```python
import torch

def _softmax(x, axis=-1):
    return torch.softmax(x, dim=axis)
def _gelu(x):
    return torch.nn.functional.gelu(x, approximate="tanh")
def _silu(x):
    return torch.nn.functional.silu(x)
def _sigmoid(x):
    return torch.sigmoid(x)
def _layernorm(x, axis=-1, eps=1e-5):
    m = x.mean(dim=axis, keepdim=True)
    v = x.var(dim=axis, keepdim=True, unbiased=False)
    return (x - m) / torch.sqrt(v + eps)
def _scatter_add(tgt, idx, src, axis=0):
    return tgt.clone().index_add_(axis, idx, src)
def _segment_sum(src, seg, n):
    out = torch.zeros((n,) + src.shape[1:], dtype=src.dtype)
    return out.index_add_(0, seg, src)
def _pad(x, pw):
    flat = tuple(v for pair in reversed(pw) for v in pair)
    return torch.nn.functional.pad(x, flat)

kernel_name = 'parallel_sum__ssm_conv_s4__dense_activation_mish__prompt'

def setup_inputs():

    _w = (lambda a: (lambda t: t.to(torch.bfloat16) if t.is_floating_point() else t)(torch.as_tensor(a)))
    def _A_setup():
        B, L, D, N = 1, 2048, 640, 192
        A_re = -(lambda _x: torch.exp(torch.as_tensor(_x)))((lambda *s: torch.randn(*s, dtype=torch.bfloat16) * 3.2)(D, N))
        A_im = torch.pi * (lambda *s: torch.randn(*s, dtype=torch.bfloat16) * 0.05)(D, N)
        B_re = (lambda *s: torch.randn(*s, dtype=torch.bfloat16) * 0.1)(D, N)
        B_im = (lambda *s: torch.randn(*s, dtype=torch.bfloat16) * 0.1)(D, N)
        C_re = (lambda *s: torch.randn(*s, dtype=torch.bfloat16) * 0.1)(D, N)
        C_im = (lambda *s: torch.randn(*s, dtype=torch.bfloat16) * 0.1)(D, N)
        log_dt = (lambda *s: torch.randn(*s, dtype=torch.bfloat16) * 0.05)(D) * 0.5 - 4.0
        Dskip = (lambda *s: torch.randn(*s, dtype=torch.bfloat16) * 0.05)(D)
        return {
            "u": _w((lambda *s: torch.randn(*s, dtype=torch.bfloat16) * 0.05)(B, L, D)),
            "A_re": _w(A_re),
            "A_im": _w(A_im),
            "B_re": _w(B_re),
            "B_im": _w(B_im),
            "C_re": _w(C_re),
            "C_im": _w(C_im),
            "log_dt": _w(log_dt),
            "Dskip": _w(Dskip),
        }
    _A_in = _A_setup()

    def _B_setup():
        B, S, D, F = 1, 2048, 640, 1536
        return {
            "x": _w((lambda *s: torch.randn(*s, dtype=torch.bfloat16) * 0.05)(B, S, D)),
            "w1": _w((lambda *s: torch.randn(*s, dtype=torch.bfloat16) * 0.8)(D, F) * (D ** -0.5)),
            "b1": _w((lambda *s: torch.randn(*s, dtype=torch.bfloat16) * 0.4)(F)),
            "w2": _w((lambda *s: torch.randn(*s, dtype=torch.bfloat16) * 0.2)(F, D) * (F ** -0.5)),
        }
    _B_in = _B_setup()

    return {
        "A_u": _A_in["u"],
        "A_A_re": _A_in["A_re"],
        "A_A_im": _A_in["A_im"],
        "A_B_re": _A_in["B_re"],
        "A_B_im": _A_in["B_im"],
        "A_C_re": _A_in["C_re"],
        "A_C_im": _A_in["C_im"],
        "A_log_dt": _A_in["log_dt"],
        "A_Dskip": _A_in["Dskip"],
        "B_x": _B_in["x"],
        "B_w1": _B_in["w1"],
        "B_b1": _B_in["b1"],
        "B_w2": _B_in["w2"],
    }

def reference(A_u, A_A_re, A_A_im, A_B_re, A_B_im, A_C_re, A_C_im, A_log_dt, A_Dskip, B_x, B_w1, B_b1, B_w2):
    def _A_ref(u, A_re, A_im, B_re, B_im, C_re, C_im, log_dt, Dskip):
        Bsz, L, D = u.shape
        dt = torch.exp(log_dt)[:, None]
        A = A_re + 1j * A_im
        Bc = B_re + 1j * B_im
        Cc = C_re + 1j * C_im
        logdA = dt * A
        dB = dt * Bc
        l = (lambda x, dt: x.to(dt))(torch.arange(L), A_re.dtype)
        P = torch.exp(logdA[:, :, None] * l[None, None, :])
        K = torch.einsum("dn,dnl,dn->dl", Cc, P, dB).real
        L2 = 2 * L
        Kp = _pad(K, ((0, 0), (0, L)))
        up = (lambda x, *d: x.permute(*d))(u, 0, 2, 1)
        up = _pad(up, ((0, 0), (0, 0), (0, L)))
        Kf = (lambda x, axes=(-2,-1): torch.fft.rfft2(x.float(), dim=axes))(Kp[:, None, :], axes=(-2, -1))
        Uf = (lambda x, axes=(-2,-1): torch.fft.rfft2(x.float(), dim=axes))(up[:, :, None, :], axes=(-2, -1))
        Yf = Uf * Kf[None, :, :, :]
        y = (lambda x, s, axes=(-2,-1): torch.fft.irfft2(x, s=s, dim=axes).to(torch.bfloat16))(Yf, (1, L2), axes=(-2, -1))[:, :, 0, :L]
        y = (lambda x, *d: x.permute(*d))(y, 0, 2, 1) + u * Dskip[None, None, :]
        return y

    def _B_ref(x, w1, b1, w2):
        h = torch.einsum("bsd,df->bsf", x, w1) + b1
        sp = torch.log1p(torch.exp(-torch.abs(h))) + torch.where(h > 0, h, torch.zeros_like(h))
        act = h * torch.tanh(sp)
        return torch.einsum("bsf,fd->bsd", act, w2)

    x = A_u
    xn = _layernorm(x, axis=-1)
    return x + _A_ref(xn, A_A_re, A_A_im, A_B_re, A_B_im, A_C_re, A_C_im, A_log_dt, A_Dskip) + _B_ref(xn, B_w1, B_b1, B_w2)
```

```asm
; @launch grid=(512,1,1) block=(256,1,1) lds=81920
.amdgcn_target "amdgcn-amd-amdhsa--gfx950"
.text
.globl parallel_sum__ssm_conv_s4__dense_activation_mish__prompt_kernel
.p2align 8
.type parallel_sum__ssm_conv_s4__dense_activation_mish__prompt_kernel,@function
parallel_sum__ssm_conv_s4__dense_activation_mish__prompt_kernel:
s_cmp_ge_u32 s2, 512
s_cbranch_scc1 L_A_end
s_load_dwordx16 s[4:19], s[0:1], 0
s_load_dwordx16 s[20:35], s[0:1], 64
v_and_b32 v1, 63, v0
v_lshrrev_b32 v2, 6, v0
s_nop 0
v_readfirstlane_b32 s52, v2
s_waitcnt lgkmcnt(0)
s_mov_b32 s36, s34
s_and_b32 s37, s35, 0xffff
s_mov_b32 s38, 22020096
s_mov_b32 s39, 0x00020000
s_mov_b32 s40, s4
s_and_b32 s41, s5, 0xffff
s_mov_b32 s42, 2621440
s_mov_b32 s43, 0x00020000
s_mov_b32 s48, s32
s_and_b32 s49, s33, 0xffff
s_mov_b32 s50, 256
s_mov_b32 s51, 0x00020000
s_cmp_ge_u32 s2, 256
s_cbranch_scc1 L_A_gemm
s_mov_b32 s44, s28
s_and_b32 s45, s29, 0xffff
s_mov_b32 s46, 1966080
s_mov_b32 s47, 0x00020000
s_and_b32 s53, s2, 255
s_and_b32 s54, s53, 7
s_mul_i32 s54, s54, 80
s_lshr_b32 s55, s53, 3
s_mul_i32 s56, s55, 3
s_lshl_b32 s57, s55, 1
s_add_u32 s57, s57, 16
s_cmp_lt_u32 s55, 16
s_cselect_b32 s63, 3, 2
s_cselect_b32 s56, s56, s57
s_add_u32 s64, s54, s56
s_cmp_eq_u32 s52, 3
s_cbranch_scc1 L_A_aux
s_cmp_ge_u32 s52, s63
s_cbranch_scc1 L_A_stage
s_add_u32 s54, s64, s52
s_mul_i32 s55, s52, 17408
s_setprio 1
s_mul_i32 s56, s54, 384
v_lshlrev_b32 v42, 2, v1
v_add_u32 v42, s56, v42
v_lshlrev_b32 v43, 1, v1
v_add_u32 v43, s56, v43
s_lshr_b32 s57, s54, 1
s_lshl_b32 s57, s57, 2
s_load_dword s58, s[18:19], s57
s_load_dword s59, s[20:21], s57
global_load_dword v2, v42, s[6:7]
global_load_dword v3, v42, s[8:9]
global_load_dword v4, v42, s[10:11]
global_load_dword v5, v42, s[12:13]
global_load_dword v6, v42, s[14:15]
global_load_dword v7, v42, s[16:17]
v_mov_b32 v8, 0
v_mov_b32 v9, 0
v_mov_b32 v10, 0
v_mov_b32 v11, 0
v_mov_b32 v12, 0
v_mov_b32 v13, 0
global_load_short_d16_hi v8, v43, s[6:7] offset:256
global_load_short_d16_hi v9, v43, s[8:9] offset:256
global_load_short_d16_hi v10, v43, s[10:11] offset:256
global_load_short_d16_hi v11, v43, s[12:13] offset:256
global_load_short_d16_hi v12, v43, s[14:15] offset:256
global_load_short_d16_hi v13, v43, s[16:17] offset:256
s_mov_b32 m0, s55
v_and_b32 v52, 31, v1
v_mul_u32_u24 v52, 272, v52
v_lshrrev_b32 v51, 5, v1
v_lshlrev_b32 v51, 4, v51
v_add_u32 v52, v52, v51
v_add_u32 v52, s55, v52
v_add_u32 v51, 8704, v52
v_mov_b32 v56, 0
v_mov_b32 v57, 0
v_mov_b32 v58, 0
v_mov_b32 v59, 0
v_mov_b32 v60, 0
v_mov_b32 v61, 0
v_mov_b32 v62, 0
v_mov_b32 v63, 0
v_mov_b32 v64, 0
v_mov_b32 v65, 0
v_mov_b32 v66, 0
v_mov_b32 v67, 0
v_mov_b32 v68, 0
v_mov_b32 v69, 0
v_mov_b32 v70, 0
v_mov_b32 v71, 0
s_waitcnt lgkmcnt(0)
s_and_b32 s57, s54, 1
s_lshl_b32 s57, s57, 4
s_lshr_b32 s58, s58, s57
s_lshl_b32 s58, s58, 16
s_lshr_b32 s59, s59, s57
s_lshl_b32 s59, s59, 16
s_mov_b32 s60, 0x3fb8aa3b
s_mov_b32 s61, 0x32a5705f
s_mov_b32 s62, 0x3f317218
v_mov_b32 v42, s58
v_mul_f32 v43, s60, v42
v_fma_f32 v44, v42, s60, -v43
v_fma_f32 v44, v42, s61, v44
v_exp_f32 v43, v43
v_mul_f32 v44, s62, v44
v_fma_f32 v43, v43, v44, v43
v_cvt_pk_bf16_f32 v43, v43, v43
v_lshlrev_b32 v22, 16, v43
v_mov_b32 v50, 0x3f80
s_waitcnt vmcnt(6)
v_lshlrev_b32 v14, 16, v2
v_lshlrev_b32 v15, 16, v3
v_lshlrev_b32 v16, 16, v4
v_lshlrev_b32 v17, 16, v5
v_lshlrev_b32 v18, 16, v6
v_lshlrev_b32 v19, 16, v7
v_mul_f32 v20, v14, v22
v_mul_f32 v21, v15, v22
v_mul_f32 v20, s60, v20
v_mul_f32 v21, 0.15915494, v21
v_mul_f32 v140, 0x41000000, v21
v_mul_f32 v137, 0x41000000, v20
v_mul_f32 v141, 0x43780000, v21
v_mul_f32 v138, 0x43780000, v20
v_fract_f32 v139, v21
v_fract_f32 v140, v140
v_fract_f32 v141, v141
v_exp_f32 v136, v20
v_exp_f32 v137, v137
v_exp_f32 v138, v138
v_sin_f32 v142, v139
v_cos_f32 v145, v139
v_sin_f32 v143, v140
v_cos_f32 v146, v140
v_sin_f32 v144, v141
v_cos_f32 v147, v141
v_mul_f32 v24, v18, v16
v_mul_f32 v25, v18, v17
v_fma_f32 v24, -v19, v17, v24
v_fma_f32 v25, v19, v16, v25
v_mul_f32 v24, v24, v22
v_mul_f32 v25, -v25, v22
v_mul_f32 v33, v136, v142
v_mul_f32 v32, v136, v145
v_mul_f32 v39, v137, v143
v_mul_f32 v38, v137, v146
v_mul_f32 v41, v138, v144
v_mul_f32 v40, v138, v147
v_pk_mul_f32 v[28:29], v[32:33], v[32:33] op_sel:[0,0] op_sel_hi:[0,1]
v_pk_fma_f32 v[34:35], v[32:33], v[32:33], v[28:29] op_sel:[1,1,0] op_sel_hi:[1,0,1] neg_lo:[0,1,0]
v_pk_mul_f32 v[28:29], v[34:35], v[34:35] op_sel:[0,0] op_sel_hi:[0,1]
v_pk_fma_f32 v[36:37], v[34:35], v[34:35], v[28:29] op_sel:[1,1,0] op_sel_hi:[1,0,1] neg_lo:[0,1,0]
ds_write_addtid_b32 v50
v_cvt_pk_bf16_f32 v46, v24, v25
v_cvt_pk_bf16_f32 v47, v38, v39
v_pk_mul_f32 v[28:29], v[38:39], v[38:39] op_sel:[0,0] op_sel_hi:[0,1]
v_pk_mul_f32 v[30:31], v[24:25], v[32:33] op_sel:[0,0] op_sel_hi:[0,1] neg_hi:[0,1]
v_pk_fma_f32 v[26:27], v[38:39], v[38:39], v[28:29] op_sel:[1,1,0] op_sel_hi:[1,0,1] neg_lo:[0,1,0]
v_pk_fma_f32 v[24:25], v[24:25], v[32:33], v[30:31] op_sel:[1,1,0] op_sel_hi:[1,0,1]
v_cvt_pk_bf16_f32 v48, v26, v27
v_cvt_pk_bf16_f32 v49, v24, v25
ds_write_addtid_b32 v46 offset:8704
ds_write_addtid_b32 v47 offset:272
v_pk_mul_f32 v[28:29], v[26:27], v[38:39] op_sel:[0,0] op_sel_hi:[0,1]
v_pk_mul_f32 v[30:31], v[24:25], v[32:33] op_sel:[0,0] op_sel_hi:[0,1] neg_hi:[0,1]
v_pk_fma_f32 v[26:27], v[26:27], v[38:39], v[28:29] op_sel:[1,1,0] op_sel_hi:[1,0,1] neg_lo:[0,1,0]
v_pk_fma_f32 v[24:25], v[24:25], v[32:33], v[30:31] op_sel:[1,1,0] op_sel_hi:[1,0,1]
v_cvt_pk_bf16_f32 v46, v26, v27
v_cvt_pk_bf16_f32 v47, v24, v25
ds_write_addtid_b32 v48 offset:544
ds_write_addtid_b32 v49 offset:8976
v_pk_mul_f32 v[28:29], v[26:27], v[38:39] op_sel:[0,0] op_sel_hi:[0,1]
v_pk_mul_f32 v[30:31], v[24:25], v[32:33] op_sel:[0,0] op_sel_hi:[0,1] neg_hi:[0,1]
v_pk_fma_f32 v[26:27], v[26:27], v[38:39], v[28:29] op_sel:[1,1,0] op_sel_hi:[1,0,1] neg_lo:[0,1,0]
v_pk_fma_f32 v[24:25], v[24:25], v[32:33], v[30:31] op_sel:[1,1,0] op_sel_hi:[1,0,1]
v_cvt_pk_bf16_f32 v48, v26, v27
v_cvt_pk_bf16_f32 v49, v24, v25
ds_write_addtid_b32 v46 offset:816
ds_write_addtid_b32 v47 offset:9248
v_pk_mul_f32 v[28:29], v[26:27], v[38:39] op_sel:[0,0] op_sel_hi:[0,1]
v_pk_mul_f32 v[30:31], v[24:25], v[32:33] op_sel:[0,0] op_sel_hi:[0,1] neg_hi:[0,1]
v_pk_fma_f32 v[26:27], v[26:27], v[38:39], v[28:29] op_sel:[1,1,0] op_sel_hi:[1,0,1] neg_lo:[0,1,0]
v_pk_fma_f32 v[24:25], v[24:25], v[32:33], v[30:31] op_sel:[1,1,0] op_sel_hi:[1,0,1]
v_cvt_pk_bf16_f32 v46, v26, v27
v_cvt_pk_bf16_f32 v47, v24, v25
ds_write_addtid_b32 v48 offset:1088
ds_write_addtid_b32 v49 offset:9520
v_pk_mul_f32 v[28:29], v[26:27], v[38:39] op_sel:[0,0] op_sel_hi:[0,1]
v_pk_mul_f32 v[30:31], v[24:25], v[32:33] op_sel:[0,0] op_sel_hi:[0,1] neg_hi:[0,1]
v_pk_fma_f32 v[26:27], v[26:27], v[38:39], v[28:29] op_sel:[1,1,0] op_sel_hi:[1,0,1] neg_lo:[0,1,0]
v_pk_fma_f32 v[24:25], v[24:25], v[32:33], v[30:31] op_sel:[1,1,0] op_sel_hi:[1,0,1]
v_cvt_pk_bf16_f32 v48, v26, v27
v_cvt_pk_bf16_f32 v49, v24, v25
ds_write_addtid_b32 v46 offset:1360
ds_write_addtid_b32 v47 offset:9792
v_pk_mul_f32 v[28:29], v[26:27], v[38:39] op_sel:[0,0] op_sel_hi:[0,1]
v_pk_mul_f32 v[30:31], v[24:25], v[32:33] op_sel:[0,0] op_sel_hi:[0,1] neg_hi:[0,1]
v_pk_fma_f32 v[26:27], v[26:27], v[38:39], v[28:29] op_sel:[1,1,0] op_sel_hi:[1,0,1] neg_lo:[0,1,0]
v_pk_fma_f32 v[24:25], v[24:25], v[32:33], v[30:31] op_sel:[1,1,0] op_sel_hi:[1,0,1]
v_cvt_pk_bf16_f32 v46, v26, v27
v_cvt_pk_bf16_f32 v47, v24, v25
ds_write_addtid_b32 v48 offset:1632
ds_write_addtid_b32 v49 offset:10064
v_pk_mul_f32 v[28:29], v[26:27], v[38:39] op_sel:[0,0] op_sel_hi:[0,1]
v_pk_mul_f32 v[30:31], v[24:25], v[32:33] op_sel:[0,0] op_sel_hi:[0,1] neg_hi:[0,1]
v_pk_fma_f32 v[26:27], v[26:27], v[38:39], v[28:29] op_sel:[1,1,0] op_sel_hi:[1,0,1] neg_lo:[0,1,0]
v_pk_fma_f32 v[24:25], v[24:25], v[32:33], v[30:31] op_sel:[1,1,0] op_sel_hi:[1,0,1]
v_cvt_pk_bf16_f32 v48, v26, v27
v_cvt_pk_bf16_f32 v49, v24, v25
ds_write_addtid_b32 v46 offset:1904
ds_write_addtid_b32 v47 offset:10336
v_pk_mul_f32 v[28:29], v[26:27], v[38:39] op_sel:[0,0] op_sel_hi:[0,1]
v_pk_mul_f32 v[30:31], v[24:25], v[32:33] op_sel:[0,0] op_sel_hi:[0,1] neg_hi:[0,1]
v_pk_fma_f32 v[26:27], v[26:27], v[38:39], v[28:29] op_sel:[1,1,0] op_sel_hi:[1,0,1] neg_lo:[0,1,0]
v_pk_fma_f32 v[24:25], v[24:25], v[32:33], v[30:31] op_sel:[1,1,0] op_sel_hi:[1,0,1]
v_cvt_pk_bf16_f32 v46, v26, v27
ds_write_addtid_b32 v48 offset:2176
ds_write_addtid_b32 v49 offset:10608
v_pk_mul_f32 v[28:29], v[26:27], v[38:39] op_sel:[0,0] op_sel_hi:[0,1]
v_pk_mul_f32 v[30:31], v[24:25], v[40:41] op_sel:[0,0] op_sel_hi:[0,1] neg_hi:[0,1]
v_pk_fma_f32 v[26:27], v[26:27], v[38:39], v[28:29] op_sel:[1,1,0] op_sel_hi:[1,0,1] neg_lo:[0,1,0]
v_pk_fma_f32 v[24:25], v[24:25], v[40:41], v[30:31] op_sel:[1,1,0] op_sel_hi:[1,0,1]
v_cvt_pk_bf16_f32 v47, v26, v27
v_cvt_pk_bf16_f32 v48, v24, v25
ds_write_addtid_b32 v46 offset:2448
v_pk_mul_f32 v[28:29], v[26:27], v[38:39] op_sel:[0,0] op_sel_hi:[0,1]
v_pk_mul_f32 v[30:31], v[24:25], v[34:35] op_sel:[0,0] op_sel_hi:[0,1] neg_hi:[0,1]
v_pk_fma_f32 v[26:27], v[26:27], v[38:39], v[28:29] op_sel:[1,1,0] op_sel_hi:[1,0,1] neg_lo:[0,1,0]
v_pk_fma_f32 v[24:25], v[24:25], v[34:35], v[30:31] op_sel:[1,1,0] op_sel_hi:[1,0,1]
v_cvt_pk_bf16_f32 v49, v26, v27
v_cvt_pk_bf16_f32 v46, v24, v25
ds_write_addtid_b32 v47 offset:2720
ds_write_addtid_b32 v48 offset:10880
v_pk_mul_f32 v[28:29], v[26:27], v[38:39] op_sel:[0,0] op_sel_hi:[0,1]
v_pk_mul_f32 v[30:31], v[24:25], v[34:35] op_sel:[0,0] op_sel_hi:[0,1] neg_hi:[0,1]
v_pk_fma_f32 v[26:27], v[26:27], v[38:39], v[28:29] op_sel:[1,1,0] op_sel_hi:[1,0,1] neg_lo:[0,1,0]
v_pk_fma_f32 v[24:25], v[24:25], v[34:35], v[30:31] op_sel:[1,1,0] op_sel_hi:[1,0,1]
v_cvt_pk_bf16_f32 v47, v26, v27
v_cvt_pk_bf16_f32 v48, v24, v25
ds_write_addtid_b32 v49 offset:2992
ds_write_addtid_b32 v46 offset:11152
v_pk_mul_f32 v[28:29], v[26:27], v[38:39] op_sel:[0,0] op_sel_hi:[0,1]
v_pk_mul_f32 v[30:31], v[24:25], v[34:35] op_sel:[0,0] op_sel_hi:[0,1] neg_hi:[0,1]
v_pk_fma_f32 v[26:27], v[26:27], v[38:39], v[28:29] op_sel:[1,1,0] op_sel_hi:[1,0,1] neg_lo:[0,1,0]
v_pk_fma_f32 v[24:25], v[24:25], v[34:35], v[30:31] op_sel:[1,1,0] op_sel_hi:[1,0,1]
v_cvt_pk_bf16_f32 v49, v26, v27
v_cvt_pk_bf16_f32 v46, v24, v25
ds_write_addtid_b32 v47 offset:3264
ds_write_addtid_b32 v48 offset:11424
ds_write_addtid_b32 v48 offset:11968
v_pk_mul_f32 v[28:29], v[26:27], v[38:39] op_sel:[0,0] op_sel_hi:[0,1]
v_pk_mul_f32 v[30:31], v[24:25], v[34:35] op_sel:[0,0] op_sel_hi:[0,1] neg_hi:[0,1]
v_pk_fma_f32 v[26:27], v[26:27], v[38:39], v[28:29] op_sel:[1,1,0] op_sel_hi:[1,0,1] neg_lo:[0,1,0]
v_pk_fma_f32 v[24:25], v[24:25], v[34:35], v[30:31] op_sel:[1,1,0] op_sel_hi:[1,0,1]
v_cvt_pk_bf16_f32 v47, v26, v27
v_cvt_pk_bf16_f32 v48, v24, v25
ds_write_addtid_b32 v49 offset:3536
ds_write_addtid_b32 v46 offset:12240
v_pk_mul_f32 v[28:29], v[26:27], v[38:39] op_sel:[0,0] op_sel_hi:[0,1]
v_pk_mul_f32 v[30:31], v[24:25], v[40:41] op_sel:[0,0] op_sel_hi:[0,1] neg_hi:[0,1]
v_pk_fma_f32 v[26:27], v[26:27], v[38:39], v[28:29] op_sel:[1,1,0] op_sel_hi:[1,0,1] neg_lo:[0,1,0]
v_pk_fma_f32 v[24:25], v[24:25], v[40:41], v[30:31] op_sel:[1,1,0] op_sel_hi:[1,0,1]
v_cvt_pk_bf16_f32 v49, v26, v27
v_cvt_pk_bf16_f32 v46, v24, v25
ds_write_addtid_b32 v47 offset:3808
ds_write_addtid_b32 v48 offset:12512
v_pk_mul_f32 v[28:29], v[26:27], v[38:39] op_sel:[0,0] op_sel_hi:[0,1]
v_pk_mul_f32 v[30:31], v[24:25], v[36:37] op_sel:[0,0] op_sel_hi:[0,1] neg_hi:[0,1]
v_pk_fma_f32 v[26:27], v[26:27], v[38:39], v[28:29] op_sel:[1,1,0] op_sel_hi:[1,0,1] neg_lo:[0,1,0]
v_pk_fma_f32 v[24:25], v[24:25], v[36:37], v[30:31] op_sel:[1,1,0] op_sel_hi:[1,0,1]
v_cvt_pk_bf16_f32 v47, v26, v27
v_cvt_pk_bf16_f32 v48, v24, v25
ds_write_addtid_b32 v49 offset:4080
ds_write_addtid_b32 v46 offset:13056
v_pk_mul_f32 v[28:29], v[26:27], v[38:39] op_sel:[0,0] op_sel_hi:[0,1]
v_pk_mul_f32 v[30:31], v[24:25], v[36:37] op_sel:[0,0] op_sel_hi:[0,1] neg_hi:[0,1]
v_pk_fma_f32 v[26:27], v[26:27], v[38:39], v[28:29] op_sel:[1,1,0] op_sel_hi:[1,0,1] neg_lo:[0,1,0]
v_pk_fma_f32 v[24:25], v[24:25], v[36:37], v[30:31] op_sel:[1,1,0] op_sel_hi:[1,0,1]
v_cvt_pk_bf16_f32 v49, v26, v27
v_cvt_pk_bf16_f32 v46, v24, v25
ds_write_addtid_b32 v47 offset:4352
ds_write_addtid_b32 v48 offset:13328
ds_write_addtid_b32 v48 offset:14144
v_pk_mul_f32 v[28:29], v[26:27], v[38:39] op_sel:[0,0] op_sel_hi:[0,1]
v_pk_mul_f32 v[30:31], v[24:25], v[40:41] op_sel:[0,0] op_sel_hi:[0,1] neg_hi:[0,1]
v_pk_fma_f32 v[26:27], v[26:27], v[38:39], v[28:29] op_sel:[1,1,0] op_sel_hi:[1,0,1] neg_lo:[0,1,0]
v_pk_fma_f32 v[24:25], v[24:25], v[40:41], v[30:31] op_sel:[1,1,0] op_sel_hi:[1,0,1]
v_cvt_pk_bf16_f32 v47, v26, v27
v_cvt_pk_bf16_f32 v48, v24, v25
ds_write_addtid_b32 v49 offset:4624
ds_write_addtid_b32 v46 offset:14416
v_pk_mul_f32 v[28:29], v[26:27], v[38:39] op_sel:[0,0] op_sel_hi:[0,1]
v_pk_mul_f32 v[30:31], v[24:25], v[36:37] op_sel:[0,0] op_sel_hi:[0,1] neg_hi:[0,1]
v_pk_fma_f32 v[26:27], v[26:27], v[38:39], v[28:29] op_sel:[1,1,0] op_sel_hi:[1,0,1] neg_lo:[0,1,0]
v_pk_fma_f32 v[24:25], v[24:25], v[36:37], v[30:31] op_sel:[1,1,0] op_sel_hi:[1,0,1]
v_cvt_pk_bf16_f32 v49, v26, v27
v_cvt_pk_bf16_f32 v46, v24, v25
ds_write_addtid_b32 v47 offset:4896
ds_write_addtid_b32 v48 offset:13600
v_pk_mul_f32 v[28:29], v[26:27], v[38:39] op_sel:[0,0] op_sel_hi:[0,1]
v_pk_mul_f32 v[30:31], v[24:25], v[36:37] op_sel:[0,0] op_sel_hi:[0,1] neg_hi:[0,1]
v_pk_fma_f32 v[26:27], v[26:27], v[38:39], v[28:29] op_sel:[1,1,0] op_sel_hi:[1,0,1] neg_lo:[0,1,0]
v_pk_fma_f32 v[24:25], v[24:25], v[36:37], v[30:31] op_sel:[1,1,0] op_sel_hi:[1,0,1]
v_cvt_pk_bf16_f32 v47, v26, v27
v_cvt_pk_bf16_f32 v48, v24, v25
ds_write_addtid_b32 v49 offset:5168
ds_write_addtid_b32 v46 offset:13872
ds_write_addtid_b32 v46 offset:14688
v_pk_mul_f32 v[28:29], v[26:27], v[38:39] op_sel:[0,0] op_sel_hi:[0,1]
v_pk_mul_f32 v[30:31], v[24:25], v[40:41] op_sel:[0,0] op_sel_hi:[0,1] neg_hi:[0,1]
v_pk_fma_f32 v[26:27], v[26:27], v[38:39], v[28:29] op_sel:[1,1,0] op_sel_hi:[1,0,1] neg_lo:[0,1,0]
v_pk_fma_f32 v[24:25], v[24:25], v[40:41], v[30:31] op_sel:[1,1,0] op_sel_hi:[1,0,1]
v_cvt_pk_bf16_f32 v49, v26, v27
v_cvt_pk_bf16_f32 v46, v24, v25
ds_write_addtid_b32 v47 offset:5440
ds_write_addtid_b32 v48 offset:14960
v_pk_mul_f32 v[28:29], v[26:27], v[38:39] op_sel:[0,0] op_sel_hi:[0,1]
v_pk_mul_f32 v[30:31], v[24:25], v[38:39] op_sel:[0,0] op_sel_hi:[0,1] neg_hi:[0,1]
v_pk_fma_f32 v[26:27], v[26:27], v[38:39], v[28:29] op_sel:[1,1,0] op_sel_hi:[1,0,1] neg_lo:[0,1,0]
v_pk_fma_f32 v[24:25], v[24:25], v[38:39], v[30:31] op_sel:[1,1,0] op_sel_hi:[1,0,1]
v_cvt_pk_bf16_f32 v47, v26, v27
v_cvt_pk_bf16_f32 v48, v24, v25
ds_write_addtid_b32 v49 offset:5712
ds_write_addtid_b32 v46 offset:15232
v_pk_mul_f32 v[28:29], v[26:27], v[38:39] op_sel:[0,0] op_sel_hi:[0,1]
v_pk_mul_f32 v[30:31], v[24:25], v[40:41] op_sel:[0,0] op_sel_hi:[0,1] neg_hi:[0,1]
v_pk_fma_f32 v[26:27], v[26:27], v[38:39], v[28:29] op_sel:[1,1,0] op_sel_hi:[1,0,1] neg_lo:[0,1,0]
v_pk_fma_f32 v[24:25], v[24:25], v[40:41], v[30:31] op_sel:[1,1,0] op_sel_hi:[1,0,1]
v_cvt_pk_bf16_f32 v49, v26, v27
v_cvt_pk_bf16_f32 v46, v24, v25
ds_write_addtid_b32 v47 offset:5984
ds_write_addtid_b32 v48 offset:16320
v_pk_mul_f32 v[28:29], v[26:27], v[38:39] op_sel:[0,0] op_sel_hi:[0,1]
v_pk_mul_f32 v[30:31], v[24:25], v[38:39] op_sel:[0,0] op_sel_hi:[0,1] neg_hi:[0,1]
v_pk_fma_f32 v[26:27], v[26:27], v[38:39], v[28:29] op_sel:[1,1,0] op_sel_hi:[1,0,1] neg_lo:[0,1,0]
v_pk_fma_f32 v[24:25], v[24:25], v[38:39], v[30:31] op_sel:[1,1,0] op_sel_hi:[1,0,1]
v_cvt_pk_bf16_f32 v47, v26, v27
v_cvt_pk_bf16_f32 v48, v24, v25
ds_write_addtid_b32 v49 offset:6256
ds_write_addtid_b32 v46 offset:15504
v_pk_mul_f32 v[28:29], v[26:27], v[38:39] op_sel:[0,0] op_sel_hi:[0,1]
v_pk_mul_f32 v[30:31], v[24:25], v[40:41] op_sel:[0,0] op_sel_hi:[0,1] neg_hi:[0,1]
v_pk_fma_f32 v[26:27], v[26:27], v[38:39], v[28:29] op_sel:[1,1,0] op_sel_hi:[1,0,1] neg_lo:[0,1,0]
v_pk_fma_f32 v[24:25], v[24:25], v[40:41], v[30:31] op_sel:[1,1,0] op_sel_hi:[1,0,1]
v_cvt_pk_bf16_f32 v49, v26, v27
v_cvt_pk_bf16_f32 v46, v24, v25
ds_write_addtid_b32 v47 offset:6528
ds_write_addtid_b32 v48 offset:16592
v_pk_mul_f32 v[28:29], v[26:27], v[38:39] op_sel:[0,0] op_sel_hi:[0,1]
v_pk_mul_f32 v[30:31], v[24:25], v[38:39] op_sel:[0,0] op_sel_hi:[0,1] neg_hi:[0,1]
v_pk_fma_f32 v[26:27], v[26:27], v[38:39], v[28:29] op_sel:[1,1,0] op_sel_hi:[1,0,1] neg_lo:[0,1,0]
v_pk_fma_f32 v[24:25], v[24:25], v[38:39], v[30:31] op_sel:[1,1,0] op_sel_hi:[1,0,1]
v_cvt_pk_bf16_f32 v47, v26, v27
v_cvt_pk_bf16_f32 v48, v24, v25
ds_write_addtid_b32 v49 offset:6800
ds_write_addtid_b32 v46 offset:15776
v_pk_mul_f32 v[28:29], v[26:27], v[38:39] op_sel:[0,0] op_sel_hi:[0,1]
v_pk_mul_f32 v[30:31], v[24:25], v[40:41] op_sel:[0,0] op_sel_hi:[0,1] neg_hi:[0,1]
v_pk_fma_f32 v[26:27], v[26:27], v[38:39], v[28:29] op_sel:[1,1,0] op_sel_hi:[1,0,1] neg_lo:[0,1,0]
v_pk_fma_f32 v[24:25], v[24:25], v[40:41], v[30:31] op_sel:[1,1,0] op_sel_hi:[1,0,1]
v_cvt_pk_bf16_f32 v49, v26, v27
v_cvt_pk_bf16_f32 v46, v24, v25
ds_write_addtid_b32 v47 offset:7072
ds_write_addtid_b32 v48 offset:16864
v_pk_mul_f32 v[28:29], v[26:27], v[38:39] op_sel:[0,0] op_sel_hi:[0,1]
v_pk_mul_f32 v[30:31], v[24:25], v[38:39] op_sel:[0,0] op_sel_hi:[0,1] neg_hi:[0,1]
v_pk_fma_f32 v[26:27], v[26:27], v[38:39], v[28:29] op_sel:[1,1,0] op_sel_hi:[1,0,1] neg_lo:[0,1,0]
v_pk_fma_f32 v[24:25], v[24:25], v[38:39], v[30:31] op_sel:[1,1,0] op_sel_hi:[1,0,1]
v_cvt_pk_bf16_f32 v47, v26, v27
v_cvt_pk_bf16_f32 v48, v24, v25
ds_write_addtid_b32 v49 offset:7344
ds_write_addtid_b32 v46 offset:16048
v_pk_mul_f32 v[28:29], v[26:27], v[38:39] op_sel:[0,0] op_sel_hi:[0,1]
v_pk_fma_f32 v[26:27], v[26:27], v[38:39], v[28:29] op_sel:[1,1,0] op_sel_hi:[1,0,1] neg_lo:[0,1,0]
v_cvt_pk_bf16_f32 v49, v26, v27
ds_write_addtid_b32 v47 offset:7616
ds_write_addtid_b32 v48 offset:17136
v_pk_mul_f32 v[28:29], v[26:27], v[38:39] op_sel:[0,0] op_sel_hi:[0,1]
v_pk_fma_f32 v[26:27], v[26:27], v[38:39], v[28:29] op_sel:[1,1,0] op_sel_hi:[1,0,1] neg_lo:[0,1,0]
v_cvt_pk_bf16_f32 v46, v26, v27
ds_write_addtid_b32 v49 offset:7888
v_pk_mul_f32 v[28:29], v[26:27], v[38:39] op_sel:[0,0] op_sel_hi:[0,1]
v_pk_fma_f32 v[26:27], v[26:27], v[38:39], v[28:29] op_sel:[1,1,0] op_sel_hi:[1,0,1] neg_lo:[0,1,0]
v_cvt_pk_bf16_f32 v47, v26, v27
ds_write_addtid_b32 v46 offset:8160
ds_write_addtid_b32 v47 offset:8432
s_waitcnt lgkmcnt(0)
ds_read_b128 v[72:75], v51 offset:0
ds_read_b128 v[76:79], v52 offset:0
ds_read_b128 v[80:83], v51 offset:32
ds_read_b128 v[84:87], v52 offset:32
ds_read_b128 v[88:91], v51 offset:64
ds_read_b128 v[92:95], v52 offset:64
ds_read_b128 v[96:99], v51 offset:96
ds_read_b128 v[100:103], v52 offset:96
ds_read_b128 v[104:107], v51 offset:128
ds_read_b128 v[108:111], v52 offset:128
ds_read_b128 v[112:115], v51 offset:160
ds_read_b128 v[116:119], v52 offset:160
ds_read_b128 v[120:123], v51 offset:192
ds_read_b128 v[124:127], v52 offset:192
ds_read_b128 v[128:131], v51 offset:224
ds_read_b128 v[132:135], v52 offset:224
v_and_b32 v14, 0xffff0000, v2
v_and_b32 v15, 0xffff0000, v3
v_and_b32 v16, 0xffff0000, v4
v_and_b32 v17, 0xffff0000, v5
v_and_b32 v18, 0xffff0000, v6
v_and_b32 v19, 0xffff0000, v7
v_mul_f32 v20, v14, v22
v_mul_f32 v21, v15, v22
v_mul_f32 v20, s60, v20
v_mul_f32 v21, 0.15915494, v21
v_mul_f32 v140, 0x41000000, v21
v_mul_f32 v137, 0x41000000, v20
v_mul_f32 v141, 0x43780000, v21
v_mul_f32 v138, 0x43780000, v20
v_fract_f32 v139, v21
v_fract_f32 v140, v140
v_fract_f32 v141, v141
v_exp_f32 v136, v20
v_exp_f32 v137, v137
v_exp_f32 v138, v138
v_sin_f32 v142, v139
v_cos_f32 v145, v139
v_sin_f32 v143, v140
v_cos_f32 v146, v140
v_sin_f32 v144, v141
v_cos_f32 v147, v141
v_mul_f32 v24, v18, v16
v_mul_f32 v25, v18, v17
v_fma_f32 v24, -v19, v17, v24
v_fma_f32 v25, v19, v16, v25
v_mul_f32 v24, v24, v22
v_mul_f32 v25, -v25, v22
v_mul_f32 v33, v136, v142
v_mul_f32 v32, v136, v145
v_mul_f32 v39, v137, v143
v_mul_f32 v38, v137, v146
v_mul_f32 v41, v138, v144
v_mul_f32 v40, v138, v147
v_pk_mul_f32 v[28:29], v[32:33], v[32:33] op_sel:[0,0] op_sel_hi:[0,1]
v_pk_fma_f32 v[34:35], v[32:33], v[32:33], v[28:29] op_sel:[1,1,0] op_sel_hi:[1,0,1] neg_lo:[0,1,0]
v_pk_mul_f32 v[28:29], v[34:35], v[34:35] op_sel:[0,0] op_sel_hi:[0,1]
v_pk_fma_f32 v[36:37], v[34:35], v[34:35], v[28:29] op_sel:[1,1,0] op_sel_hi:[1,0,1] neg_lo:[0,1,0]
s_waitcnt lgkmcnt(0)
ds_write_addtid_b32 v50
v_cvt_pk_bf16_f32 v46, v24, v25
v_cvt_pk_bf16_f32 v47, v38, v39
v_pk_mul_f32 v[28:29], v[38:39], v[38:39] op_sel:[0,0] op_sel_hi:[0,1]
v_pk_mul_f32 v[30:31], v[24:25], v[32:33] op_sel:[0,0] op_sel_hi:[0,1] neg_hi:[0,1]
v_pk_fma_f32 v[26:27], v[38:39], v[38:39], v[28:29] op_sel:[1,1,0] op_sel_hi:[1,0,1] neg_lo:[0,1,0]
v_pk_fma_f32 v[24:25], v[24:25], v[32:33], v[30:31] op_sel:[1,1,0] op_sel_hi:[1,0,1]
v_cvt_pk_bf16_f32 v48, v26, v27
v_cvt_pk_bf16_f32 v49, v24, v25
ds_write_addtid_b32 v46 offset:8704
ds_write_addtid_b32 v47 offset:272
v_pk_mul_f32 v[28:29], v[26:27], v[38:39] op_sel:[0,0] op_sel_hi:[0,1]
v_pk_mul_f32 v[30:31], v[24:25], v[32:33] op_sel:[0,0] op_sel_hi:[0,1] neg_hi:[0,1]
v_pk_fma_f32 v[26:27], v[26:27], v[38:39], v[28:29] op_sel:[1,1,0] op_sel_hi:[1,0,1] neg_lo:[0,1,0]
v_pk_fma_f32 v[24:25], v[24:25], v[32:33], v[30:31] op_sel:[1,1,0] op_sel_hi:[1,0,1]
v_cvt_pk_bf16_f32 v46, v26, v27
v_cvt_pk_bf16_f32 v47, v24, v25
ds_write_addtid_b32 v48 offset:544
ds_write_addtid_b32 v49 offset:8976
v_mfma_f32_32x32x16_bf16 v[56:71], v[72:75], v[76:79], v[56:71]
v_pk_mul_f32 v[28:29], v[26:27], v[38:39] op_sel:[0,0] op_sel_hi:[0,1]
v_pk_mul_f32 v[30:31], v[24:25], v[32:33] op_sel:[0,0] op_sel_hi:[0,1] neg_hi:[0,1]
v_pk_fma_f32 v[26:27], v[26:27], v[38:39], v[28:29] op_sel:[1,1,0] op_sel_hi:[1,0,1] neg_lo:[0,1,0]
v_pk_fma_f32 v[24:25], v[24:25], v[32:33], v[30:31] op_sel:[1,1,0] op_sel_hi:[1,0,1]
v_cvt_pk_bf16_f32 v48, v26, v27
v_cvt_pk_bf16_f32 v49, v24, v25
ds_write_addtid_b32 v46 offset:816
ds_write_addtid_b32 v47 offset:9248
v_pk_mul_f32 v[28:29], v[26:27], v[38:39] op_sel:[0,0] op_sel_hi:[0,1]
v_pk_mul_f32 v[30:31], v[24:25], v[32:33] op_sel:[0,0] op_sel_hi:[0,1] neg_hi:[0,1]
v_pk_fma_f32 v[26:27], v[26:27], v[38:39], v[28:29] op_sel:[1,1,0] op_sel_hi:[1,0,1] neg_lo:[0,1,0]
v_pk_fma_f32 v[24:25], v[24:25], v[32:33], v[30:31] op_sel:[1,1,0] op_sel_hi:[1,0,1]
v_cvt_pk_bf16_f32 v46, v26, v27
v_cvt_pk_bf16_f32 v47, v24, v25
ds_write_addtid_b32 v48 offset:1088
ds_write_addtid_b32 v49 offset:9520
v_pk_mul_f32 v[28:29], v[26:27], v[38:39] op_sel:[0,0] op_sel_hi:[0,1]
v_pk_mul_f32 v[30:31], v[24:25], v[32:33] op_sel:[0,0] op_sel_hi:[0,1] neg_hi:[0,1]
v_pk_fma_f32 v[26:27], v[26:27], v[38:39], v[28:29] op_sel:[1,1,0] op_sel_hi:[1,0,1] neg_lo:[0,1,0]
v_pk_fma_f32 v[24:25], v[24:25], v[32:33], v[30:31] op_sel:[1,1,0] op_sel_hi:[1,0,1]
v_cvt_pk_bf16_f32 v48, v26, v27
v_cvt_pk_bf16_f32 v49, v24, v25
ds_write_addtid_b32 v46 offset:1360
ds_write_addtid_b32 v47 offset:9792
v_mfma_f32_32x32x16_bf16 v[56:71], v[80:83], v[84:87], v[56:71]
v_pk_mul_f32 v[28:29], v[26:27], v[38:39] op_sel:[0,0] op_sel_hi:[0,1]
v_pk_mul_f32 v[30:31], v[24:25], v[32:33] op_sel:[0,0] op_sel_hi:[0,1] neg_hi:[0,1]
v_pk_fma_f32 v[26:27], v[26:27], v[38:39], v[28:29] op_sel:[1,1,0] op_sel_hi:[1,0,1] neg_lo:[0,1,0]
v_pk_fma_f32 v[24:25], v[24:25], v[32:33], v[30:31] op_sel:[1,1,0] op_sel_hi:[1,0,1]
v_cvt_pk_bf16_f32 v46, v26, v27
v_cvt_pk_bf16_f32 v47, v24, v25
ds_write_addtid_b32 v48 offset:1632
ds_write_addtid_b32 v49 offset:10064
v_pk_mul_f32 v[28:29], v[26:27], v[38:39] op_sel:[0,0] op_sel_hi:[0,1]
v_pk_mul_f32 v[30:31], v[24:25], v[32:33] op_sel:[0,0] op_sel_hi:[0,1] neg_hi:[0,1]
v_pk_fma_f32 v[26:27], v[26:27], v[38:39], v[28:29] op_sel:[1,1,0] op_sel_hi:[1,0,1] neg_lo:[0,1,0]
v_pk_fma_f32 v[24:25], v[24:25], v[32:33], v[30:31] op_sel:[1,1,0] op_sel_hi:[1,0,1]
v_cvt_pk_bf16_f32 v48, v26, v27
v_cvt_pk_bf16_f32 v49, v24, v25
ds_write_addtid_b32 v46 offset:1904
ds_write_addtid_b32 v47 offset:10336
v_pk_mul_f32 v[28:29], v[26:27], v[38:39] op_sel:[0,0] op_sel_hi:[0,1]
v_pk_mul_f32 v[30:31], v[24:25], v[32:33] op_sel:[0,0] op_sel_hi:[0,1] neg_hi:[0,1]
v_pk_fma_f32 v[26:27], v[26:27], v[38:39], v[28:29] op_sel:[1,1,0] op_sel_hi:[1,0,1] neg_lo:[0,1,0]
v_pk_fma_f32 v[24:25], v[24:25], v[32:33], v[30:31] op_sel:[1,1,0] op_sel_hi:[1,0,1]
v_cvt_pk_bf16_f32 v46, v26, v27
ds_write_addtid_b32 v48 offset:2176
ds_write_addtid_b32 v49 offset:10608
v_mfma_f32_32x32x16_bf16 v[56:71], v[88:91], v[92:95], v[56:71]
v_pk_mul_f32 v[28:29], v[26:27], v[38:39] op_sel:[0,0] op_sel_hi:[0,1]
v_pk_mul_f32 v[30:31], v[24:25], v[40:41] op_sel:[0,0] op_sel_hi:[0,1] neg_hi:[0,1]
v_pk_fma_f32 v[26:27], v[26:27], v[38:39], v[28:29] op_sel:[1,1,0] op_sel_hi:[1,0,1] neg_lo:[0,1,0]
v_pk_fma_f32 v[24:25], v[24:25], v[40:41], v[30:31] op_sel:[1,1,0] op_sel_hi:[1,0,1]
v_cvt_pk_bf16_f32 v47, v26, v27
v_cvt_pk_bf16_f32 v48, v24, v25
ds_write_addtid_b32 v46 offset:2448
v_pk_mul_f32 v[28:29], v[26:27], v[38:39] op_sel:[0,0] op_sel_hi:[0,1]
v_pk_mul_f32 v[30:31], v[24:25], v[34:35] op_sel:[0,0] op_sel_hi:[0,1] neg_hi:[0,1]
v_pk_fma_f32 v[26:27], v[26:27], v[38:39], v[28:29] op_sel:[1,1,0] op_sel_hi:[1,0,1] neg_lo:[0,1,0]
v_pk_fma_f32 v[24:25], v[24:25], v[34:35], v[30:31] op_sel:[1,1,0] op_sel_hi:[1,0,1]
v_cvt_pk_bf16_f32 v49, v26, v27
v_cvt_pk_bf16_f32 v46, v24, v25
ds_write_addtid_b32 v47 offset:2720
ds_write_addtid_b32 v48 offset:10880
v_pk_mul_f32 v[28:29], v[26:27], v[38:39] op_sel:[0,0] op_sel_hi:[0,1]
v_pk_mul_f32 v[30:31], v[24:25], v[34:35] op_sel:[0,0] op_sel_hi:[0,1] neg_hi:[0,1]
v_pk_fma_f32 v[26:27], v[26:27], v[38:39], v[28:29] op_sel:[1,1,0] op_sel_hi:[1,0,1] neg_lo:[0,1,0]
v_pk_fma_f32 v[24:25], v[24:25], v[34:35], v[30:31] op_sel:[1,1,0] op_sel_hi:[1,0,1]
v_cvt_pk_bf16_f32 v47, v26, v27
v_cvt_pk_bf16_f32 v48, v24, v25
ds_write_addtid_b32 v49 offset:2992
ds_write_addtid_b32 v46 offset:11152
v_mfma_f32_32x32x16_bf16 v[56:71], v[96:99], v[100:103], v[56:71]
v_pk_mul_f32 v[28:29], v[26:27], v[38:39] op_sel:[0,0] op_sel_hi:[0,1]
v_pk_mul_f32 v[30:31], v[24:25], v[34:35] op_sel:[0,0] op_sel_hi:[0,1] neg_hi:[0,1]
v_pk_fma_f32 v[26:27], v[26:27], v[38:39], v[28:29] op_sel:[1,1,0] op_sel_hi:[1,0,1] neg_lo:[0,1,0]
v_pk_fma_f32 v[24:25], v[24:25], v[34:35], v[30:31] op_sel:[1,1,0] op_sel_hi:[1,0,1]
v_cvt_pk_bf16_f32 v49, v26, v27
v_cvt_pk_bf16_f32 v46, v24, v25
ds_write_addtid_b32 v47 offset:3264
ds_write_addtid_b32 v48 offset:11424
ds_write_addtid_b32 v48 offset:11968
v_pk_mul_f32 v[28:29], v[26:27], v[38:39] op_sel:[0,0] op_sel_hi:[0,1]
v_pk_mul_f32 v[30:31], v[24:25], v[34:35] op_sel:[0,0] op_sel_hi:[0,1] neg_hi:[0,1]
v_pk_fma_f32 v[26:27], v[26:27], v[38:39], v[28:29] op_sel:[1,1,0] op_sel_hi:[1,0,1] neg_lo:[0,1,0]
v_pk_fma_f32 v[24:25], v[24:25], v[34:35], v[30:31] op_sel:[1,1,0] op_sel_hi:[1,0,1]
v_cvt_pk_bf16_f32 v47, v26, v27
v_cvt_pk_bf16_f32 v48, v24, v25
ds_write_addtid_b32 v49 offset:3536
ds_write_addtid_b32 v46 offset:12240
v_pk_mul_f32 v[28:29], v[26:27], v[38:39] op_sel:[0,0] op_sel_hi:[0,1]
v_pk_mul_f32 v[30:31], v[24:25], v[40:41] op_sel:[0,0] op_sel_hi:[0,1] neg_hi:[0,1]
v_pk_fma_f32 v[26:27], v[26:27], v[38:39], v[28:29] op_sel:[1,1,0] op_sel_hi:[1,0,1] neg_lo:[0,1,0]
v_pk_fma_f32 v[24:25], v[24:25], v[40:41], v[30:31] op_sel:[1,1,0] op_sel_hi:[1,0,1]
v_cvt_pk_bf16_f32 v49, v26, v27
v_cvt_pk_bf16_f32 v46, v24, v25
ds_write_addtid_b32 v47 offset:3808
ds_write_addtid_b32 v48 offset:12512
v_mfma_f32_32x32x16_bf16 v[56:71], v[104:107], v[108:111], v[56:71]
v_pk_mul_f32 v[28:29], v[26:27], v[38:39] op_sel:[0,0] op_sel_hi:[0,1]
v_pk_mul_f32 v[30:31], v[24:25], v[36:37] op_sel:[0,0] op_sel_hi:[0,1] neg_hi:[0,1]
v_pk_fma_f32 v[26:27], v[26:27], v[38:39], v[28:29] op_sel:[1,1,0] op_sel_hi:[1,0,1] neg_lo:[0,1,0]
v_pk_fma_f32 v[24:25], v[24:25], v[36:37], v[30:31] op_sel:[1,1,0] op_sel_hi:[1,0,1]
v_cvt_pk_bf16_f32 v47, v26, v27
v_cvt_pk_bf16_f32 v48, v24, v25
ds_write_addtid_b32 v49 offset:4080
ds_write_addtid_b32 v46 offset:13056
v_pk_mul_f32 v[28:29], v[26:27], v[38:39] op_sel:[0,0] op_sel_hi:[0,1]
v_pk_mul_f32 v[30:31], v[24:25], v[36:37] op_sel:[0,0] op_sel_hi:[0,1] neg_hi:[0,1]
v_pk_fma_f32 v[26:27], v[26:27], v[38:39], v[28:29] op_sel:[1,1,0] op_sel_hi:[1,0,1] neg_lo:[0,1,0]
v_pk_fma_f32 v[24:25], v[24:25], v[36:37], v[30:31] op_sel:[1,1,0] op_sel_hi:[1,0,1]
v_cvt_pk_bf16_f32 v49, v26, v27
v_cvt_pk_bf16_f32 v46, v24, v25
ds_write_addtid_b32 v47 offset:4352
ds_write_addtid_b32 v48 offset:13328
ds_write_addtid_b32 v48 offset:14144
v_pk_mul_f32 v[28:29], v[26:27], v[38:39] op_sel:[0,0] op_sel_hi:[0,1]
v_pk_mul_f32 v[30:31], v[24:25], v[40:41] op_sel:[0,0] op_sel_hi:[0,1] neg_hi:[0,1]
v_pk_fma_f32 v[26:27], v[26:27], v[38:39], v[28:29] op_sel:[1,1,0] op_sel_hi:[1,0,1] neg_lo:[0,1,0]
v_pk_fma_f32 v[24:25], v[24:25], v[40:41], v[30:31] op_sel:[1,1,0] op_sel_hi:[1,0,1]
v_cvt_pk_bf16_f32 v47, v26, v27
v_cvt_pk_bf16_f32 v48, v24, v25
ds_write_addtid_b32 v49 offset:4624
ds_write_addtid_b32 v46 offset:14416
v_mfma_f32_32x32x16_bf16 v[56:71], v[112:115], v[116:119], v[56:71]
v_pk_mul_f32 v[28:29], v[26:27], v[38:39] op_sel:[0,0] op_sel_hi:[0,1]
v_pk_mul_f32 v[30:31], v[24:25], v[36:37] op_sel:[0,0] op_sel_hi:[0,1] neg_hi:[0,1]
v_pk_fma_f32 v[26:27], v[26:27], v[38:39], v[28:29] op_sel:[1,1,0] op_sel_hi:[1,0,1] neg_lo:[0,1,0]
v_pk_fma_f32 v[24:25], v[24:25], v[36:37], v[30:31] op_sel:[1,1,0] op_sel_hi:[1,0,1]
v_cvt_pk_bf16_f32 v49, v26, v27
v_cvt_pk_bf16_f32 v46, v24, v25
ds_write_addtid_b32 v47 offset:4896
ds_write_addtid_b32 v48 offset:13600
v_pk_mul_f32 v[28:29], v[26:27], v[38:39] op_sel:[0,0] op_sel_hi:[0,1]
v_pk_mul_f32 v[30:31], v[24:25], v[36:37] op_sel:[0,0] op_sel_hi:[0,1] neg_hi:[0,1]
v_pk_fma_f32 v[26:27], v[26:27], v[38:39], v[28:29] op_sel:[1,1,0] op_sel_hi:[1,0,1] neg_lo:[0,1,0]
v_pk_fma_f32 v[24:25], v[24:25], v[36:37], v[30:31] op_sel:[1,1,0] op_sel_hi:[1,0,1]
v_cvt_pk_bf16_f32 v47, v26, v27
v_cvt_pk_bf16_f32 v48, v24, v25
ds_write_addtid_b32 v49 offset:5168
ds_write_addtid_b32 v46 offset:13872
ds_write_addtid_b32 v46 offset:14688
v_pk_mul_f32 v[28:29], v[26:27], v[38:39] op_sel:[0,0] op_sel_hi:[0,1]
v_pk_mul_f32 v[30:31], v[24:25], v[40:41] op_sel:[0,0] op_sel_hi:[0,1] neg_hi:[0,1]
v_pk_fma_f32 v[26:27], v[26:27], v[38:39], v[28:29] op_sel:[1,1,0] op_sel_hi:[1,0,1] neg_lo:[0,1,0]
v_pk_fma_f32 v[24:25], v[24:25], v[40:41], v[30:31] op_sel:[1,1,0] op_sel_hi:[1,0,1]
v_cvt_pk_bf16_f32 v49, v26, v27
v_cvt_pk_bf16_f32 v46, v24, v25
ds_write_addtid_b32 v47 offset:5440
ds_write_addtid_b32 v48 offset:14960
v_mfma_f32_32x32x16_bf16 v[56:71], v[120:123], v[124:127], v[56:71]
v_pk_mul_f32 v[28:29], v[26:27], v[38:39] op_sel:[0,0] op_sel_hi:[0,1]
v_pk_mul_f32 v[30:31], v[24:25], v[38:39] op_sel:[0,0] op_sel_hi:[0,1] neg_hi:[0,1]
v_pk_fma_f32 v[26:27], v[26:27], v[38:39], v[28:29] op_sel:[1,1,0] op_sel_hi:[1,0,1] neg_lo:[0,1,0]
v_pk_fma_f32 v[24:25], v[24:25], v[38:39], v[30:31] op_sel:[1,1,0] op_sel_hi:[1,0,1]
v_cvt_pk_bf16_f32 v47, v26, v27
v_cvt_pk_bf16_f32 v48, v24, v25
ds_write_addtid_b32 v49 offset:5712
ds_write_addtid_b32 v46 offset:15232
v_pk_mul_f32 v[28:29], v[26:27], v[38:39] op_sel:[0,0] op_sel_hi:[0,1]
v_pk_mul_f32 v[30:31], v[24:25], v[40:41] op_sel:[0,0] op_sel_hi:[0,1] neg_hi:[0,1]
v_pk_fma_f32 v[26:27], v[26:27], v[38:39], v[28:29] op_sel:[1,1,0] op_sel_hi:[1,0,1] neg_lo:[0,1,0]
v_pk_fma_f32 v[24:25], v[24:25], v[40:41], v[30:31] op_sel:[1,1,0] op_sel_hi:[1,0,1]
v_cvt_pk_bf16_f32 v49, v26, v27
v_cvt_pk_bf16_f32 v46, v24, v25
ds_write_addtid_b32 v47 offset:5984
ds_write_addtid_b32 v48 offset:16320
v_pk_mul_f32 v[28:29], v[26:27], v[38:39] op_sel:[0,0] op_sel_hi:[0,1]
v_pk_mul_f32 v[30:31], v[24:25], v[38:39] op_sel:[0,0] op_sel_hi:[0,1] neg_hi:[0,1]
v_pk_fma_f32 v[26:27], v[26:27], v[38:39], v[28:29] op_sel:[1,1,0] op_sel_hi:[1,0,1] neg_lo:[0,1,0]
v_pk_fma_f32 v[24:25], v[24:25], v[38:39], v[30:31] op_sel:[1,1,0] op_sel_hi:[1,0,1]
v_cvt_pk_bf16_f32 v47, v26, v27
v_cvt_pk_bf16_f32 v48, v24, v25
ds_write_addtid_b32 v49 offset:6256
ds_write_addtid_b32 v46 offset:15504
v_mfma_f32_32x32x16_bf16 v[56:71], v[128:131], v[132:135], v[56:71]
v_pk_mul_f32 v[28:29], v[26:27], v[38:39] op_sel:[0,0] op_sel_hi:[0,1]
v_pk_mul_f32 v[30:31], v[24:25], v[40:41] op_sel:[0,0] op_sel_hi:[0,1] neg_hi:[0,1]
v_pk_fma_f32 v[26:27], v[26:27], v[38:39], v[28:29] op_sel:[1,1,0] op_sel_hi:[1,0,1] neg_lo:[0,1,0]
v_pk_fma_f32 v[24:25], v[24:25], v[40:41], v[30:31] op_sel:[1,1,0] op_sel_hi:[1,0,1]
v_cvt_pk_bf16_f32 v49, v26, v27
v_cvt_pk_bf16_f32 v46, v24, v25
ds_write_addtid_b32 v47 offset:6528
ds_write_addtid_b32 v48 offset:16592
v_pk_mul_f32 v[28:29], v[26:27], v[38:39] op_sel:[0,0] op_sel_hi:[0,1]
v_pk_mul_f32 v[30:31], v[24:25], v[38:39] op_sel:[0,0] op_sel_hi:[0,1] neg_hi:[0,1]
v_pk_fma_f32 v[26:27], v[26:27], v[38:39], v[28:29] op_sel:[1,1,0] op_sel_hi:[1,0,1] neg_lo:[0,1,0]
v_pk_fma_f32 v[24:25], v[24:25], v[38:39], v[30:31] op_sel:[1,1,0] op_sel_hi:[1,0,1]
v_cvt_pk_bf16_f32 v47, v26, v27
v_cvt_pk_bf16_f32 v48, v24, v25
ds_write_addtid_b32 v49 offset:6800
ds_write_addtid_b32 v46 offset:15776
v_pk_mul_f32 v[28:29], v[26:27], v[38:39] op_sel:[0,0] op_sel_hi:[0,1]
v_pk_mul_f32 v[30:31], v[24:25], v[40:41] op_sel:[0,0] op_sel_hi:[0,1] neg_hi:[0,1]
v_pk_fma_f32 v[26:27], v[26:27], v[38:39], v[28:29] op_sel:[1,1,0] op_sel_hi:[1,0,1] neg_lo:[0,1,0]
v_pk_fma_f32 v[24:25], v[24:25], v[40:41], v[30:31] op_sel:[1,1,0] op_sel_hi:[1,0,1]
v_cvt_pk_bf16_f32 v49, v26, v27
v_cvt_pk_bf16_f32 v46, v24, v25
ds_write_addtid_b32 v47 offset:7072
ds_write_addtid_b32 v48 offset:16864
v_pk_mul_f32 v[28:29], v[26:27], v[38:39] op_sel:[0,0] op_sel_hi:[0,1]
v_pk_mul_f32 v[30:31], v[24:25], v[38:39] op_sel:[0,0] op_sel_hi:[0,1] neg_hi:[0,1]
v_pk_fma_f32 v[26:27], v[26:27], v[38:39], v[28:29] op_sel:[1,1,0] op_sel_hi:[1,0,1] neg_lo:[0,1,0]
v_pk_fma_f32 v[24:25], v[24:25], v[38:39], v[30:31] op_sel:[1,1,0] op_sel_hi:[1,0,1]
v_cvt_pk_bf16_f32 v47, v26, v27
v_cvt_pk_bf16_f32 v48, v24, v25
ds_write_addtid_b32 v49 offset:7344
ds_write_addtid_b32 v46 offset:16048
v_pk_mul_f32 v[28:29], v[26:27], v[38:39] op_sel:[0,0] op_sel_hi:[0,1]
v_pk_fma_f32 v[26:27], v[26:27], v[38:39], v[28:29] op_sel:[1,1,0] op_sel_hi:[1,0,1] neg_lo:[0,1,0]
v_cvt_pk_bf16_f32 v49, v26, v27
ds_write_addtid_b32 v47 offset:7616
ds_write_addtid_b32 v48 offset:17136
v_pk_mul_f32 v[28:29], v[26:27], v[38:39] op_sel:[0,0] op_sel_hi:[0,1]
v_pk_fma_f32 v[26:27], v[26:27], v[38:39], v[28:29] op_sel:[1,1,0] op_sel_hi:[1,0,1] neg_lo:[0,1,0]
v_cvt_pk_bf16_f32 v46, v26, v27
ds_write_addtid_b32 v49 offset:7888
v_pk_mul_f32 v[28:29], v[26:27], v[38:39] op_sel:[0,0] op_sel_hi:[0,1]
v_pk_fma_f32 v[26:27], v[26:27], v[38:39], v[28:29] op_sel:[1,1,0] op_sel_hi:[1,0,1] neg_lo:[0,1,0]
v_cvt_pk_bf16_f32 v47, v26, v27
ds_write_addtid_b32 v46 offset:8160
ds_write_addtid_b32 v47 offset:8432
s_waitcnt vmcnt(0)
s_waitcnt lgkmcnt(0)
ds_read_b128 v[72:75], v51 offset:0
ds_read_b128 v[76:79], v52 offset:0
ds_read_b128 v[80:83], v51 offset:32
ds_read_b128 v[84:87], v52 offset:32
ds_read_b128 v[88:91], v51 offset:64
ds_read_b128 v[92:95], v52 offset:64
ds_read_b128 v[96:99], v51 offset:96
ds_read_b128 v[100:103], v52 offset:96
ds_read_b128 v[104:107], v51 offset:128
ds_read_b128 v[108:111], v52 offset:128
ds_read_b128 v[112:115], v51 offset:160
ds_read_b128 v[116:119], v52 offset:160
ds_read_b128 v[120:123], v51 offset:192
ds_read_b128 v[124:127], v52 offset:192
ds_read_b128 v[128:131], v51 offset:224
ds_read_b128 v[132:135], v52 offset:224
v_mul_f32 v20, v8, v22
v_mul_f32 v21, v9, v22
v_mul_f32 v20, s60, v20
v_mul_f32 v21, 0.15915494, v21
v_mul_f32 v140, 0x41000000, v21
v_mul_f32 v137, 0x41000000, v20
v_mul_f32 v141, 0x43780000, v21
v_mul_f32 v138, 0x43780000, v20
v_fract_f32 v139, v21
v_fract_f32 v140, v140
v_fract_f32 v141, v141
v_exp_f32 v136, v20
v_exp_f32 v137, v137
v_exp_f32 v138, v138
v_sin_f32 v142, v139
v_cos_f32 v145, v139
v_sin_f32 v143, v140
v_cos_f32 v146, v140
v_sin_f32 v144, v141
v_cos_f32 v147, v141
v_mul_f32 v24, v12, v10
v_mul_f32 v25, v12, v11
v_fma_f32 v24, -v13, v11, v24
v_fma_f32 v25, v13, v10, v25
v_mul_f32 v24, v24, v22
v_mul_f32 v25, -v25, v22
v_mul_f32 v33, v136, v142
v_mul_f32 v32, v136, v145
v_mul_f32 v39, v137, v143
v_mul_f32 v38, v137, v146
v_mul_f32 v41, v138, v144
v_mul_f32 v40, v138, v147
v_pk_mul_f32 v[28:29], v[32:33], v[32:33] op_sel:[0,0] op_sel_hi:[0,1]
v_pk_fma_f32 v[34:35], v[32:33], v[32:33], v[28:29] op_sel:[1,1,0] op_sel_hi:[1,0,1] neg_lo:[0,1,0]
v_pk_mul_f32 v[28:29], v[34:35], v[34:35] op_sel:[0,0] op_sel_hi:[0,1]
v_pk_fma_f32 v[36:37], v[34:35], v[34:35], v[28:29] op_sel:[1,1,0] op_sel_hi:[1,0,1] neg_lo:[0,1,0]
s_waitcnt lgkmcnt(0)
ds_write_addtid_b32 v50
v_cvt_pk_bf16_f32 v46, v24, v25
v_cvt_pk_bf16_f32 v47, v38, v39
v_pk_mul_f32 v[28:29], v[38:39], v[38:39] op_sel:[0,0] op_sel_hi:[0,1]
v_pk_mul_f32 v[30:31], v[24:25], v[32:33] op_sel:[0,0] op_sel_hi:[0,1] neg_hi:[0,1]
v_pk_fma_f32 v[26:27], v[38:39], v[38:39], v[28:29] op_sel:[1,1,0] op_sel_hi:[1,0,1] neg_lo:[0,1,0]
v_pk_fma_f32 v[24:25], v[24:25], v[32:33], v[30:31] op_sel:[1,1,0] op_sel_hi:[1,0,1]
v_cvt_pk_bf16_f32 v48, v26, v27
v_cvt_pk_bf16_f32 v49, v24, v25
ds_write_addtid_b32 v46 offset:8704
ds_write_addtid_b32 v47 offset:272
v_pk_mul_f32 v[28:29], v[26:27], v[38:39] op_sel:[0,0] op_sel_hi:[0,1]
v_pk_mul_f32 v[30:31], v[24:25], v[32:33] op_sel:[0,0] op_sel_hi:[0,1] neg_hi:[0,1]
v_pk_fma_f32 v[26:27], v[26:27], v[38:39], v[28:29] op_sel:[1,1,0] op_sel_hi:[1,0,1] neg_lo:[0,1,0]
v_pk_fma_f32 v[24:25], v[24:25], v[32:33], v[30:31] op_sel:[1,1,0] op_sel_hi:[1,0,1]
v_cvt_pk_bf16_f32 v46, v26, v27
v_cvt_pk_bf16_f32 v47, v24, v25
ds_write_addtid_b32 v48 offset:544
ds_write_addtid_b32 v49 offset:8976
v_mfma_f32_32x32x16_bf16 v[56:71], v[72:75], v[76:79], v[56:71]
v_pk_mul_f32 v[28:29], v[26:27], v[38:39] op_sel:[0,0] op_sel_hi:[0,1]
v_pk_mul_f32 v[30:31], v[24:25], v[32:33] op_sel:[0,0] op_sel_hi:[0,1] neg_hi:[0,1]
v_pk_fma_f32 v[26:27], v[26:27], v[38:39], v[28:29] op_sel:[1,1,0] op_sel_hi:[1,0,1] neg_lo:[0,1,0]
v_pk_fma_f32 v[24:25], v[24:25], v[32:33], v[30:31] op_sel:[1,1,0] op_sel_hi:[1,0,1]
v_cvt_pk_bf16_f32 v48, v26, v27
v_cvt_pk_bf16_f32 v49, v24, v25
ds_write_addtid_b32 v46 offset:816
ds_write_addtid_b32 v47 offset:9248
v_pk_mul_f32 v[28:29], v[26:27], v[38:39] op_sel:[0,0] op_sel_hi:[0,1]
v_pk_mul_f32 v[30:31], v[24:25], v[32:33] op_sel:[0,0] op_sel_hi:[0,1] neg_hi:[0,1]
v_pk_fma_f32 v[26:27], v[26:27], v[38:39], v[28:29] op_sel:[1,1,0] op_sel_hi:[1,0,1] neg_lo:[0,1,0]
v_pk_fma_f32 v[24:25], v[24:25], v[32:33], v[30:31] op_sel:[1,1,0] op_sel_hi:[1,0,1]
v_cvt_pk_bf16_f32 v46, v26, v27
v_cvt_pk_bf16_f32 v47, v24, v25
ds_write_addtid_b32 v48 offset:1088
ds_write_addtid_b32 v49 offset:9520
v_pk_mul_f32 v[28:29], v[26:27], v[38:39] op_sel:[0,0] op_sel_hi:[0,1]
v_pk_mul_f32 v[30:31], v[24:25], v[32:33] op_sel:[0,0] op_sel_hi:[0,1] neg_hi:[0,1]
v_pk_fma_f32 v[26:27], v[26:27], v[38:39], v[28:29] op_sel:[1,1,0] op_sel_hi:[1,0,1] neg_lo:[0,1,0]
v_pk_fma_f32 v[24:25], v[24:25], v[32:33], v[30:31] op_sel:[1,1,0] op_sel_hi:[1,0,1]
v_cvt_pk_bf16_f32 v48, v26, v27
v_cvt_pk_bf16_f32 v49, v24, v25
ds_write_addtid_b32 v46 offset:1360
ds_write_addtid_b32 v47 offset:9792
v_mfma_f32_32x32x16_bf16 v[56:71], v[80:83], v[84:87], v[56:71]
v_pk_mul_f32 v[28:29], v[26:27], v[38:39] op_sel:[0,0] op_sel_hi:[0,1]
v_pk_mul_f32 v[30:31], v[24:25], v[32:33] op_sel:[0,0] op_sel_hi:[0,1] neg_hi:[0,1]
v_pk_fma_f32 v[26:27], v[26:27], v[38:39], v[28:29] op_sel:[1,1,0] op_sel_hi:[1,0,1] neg_lo:[0,1,0]
v_pk_fma_f32 v[24:25], v[24:25], v[32:33], v[30:31] op_sel:[1,1,0] op_sel_hi:[1,0,1]
v_cvt_pk_bf16_f32 v46, v26, v27
v_cvt_pk_bf16_f32 v47, v24, v25
ds_write_addtid_b32 v48 offset:1632
ds_write_addtid_b32 v49 offset:10064
v_pk_mul_f32 v[28:29], v[26:27], v[38:39] op_sel:[0,0] op_sel_hi:[0,1]
v_pk_mul_f32 v[30:31], v[24:25], v[32:33] op_sel:[0,0] op_sel_hi:[0,1] neg_hi:[0,1]
v_pk_fma_f32 v[26:27], v[26:27], v[38:39], v[28:29] op_sel:[1,1,0] op_sel_hi:[1,0,1] neg_lo:[0,1,0]
v_pk_fma_f32 v[24:25], v[24:25], v[32:33], v[30:31] op_sel:[1,1,0] op_sel_hi:[1,0,1]
v_cvt_pk_bf16_f32 v48, v26, v27
v_cvt_pk_bf16_f32 v49, v24, v25
ds_write_addtid_b32 v46 offset:1904
ds_write_addtid_b32 v47 offset:10336
v_pk_mul_f32 v[28:29], v[26:27], v[38:39] op_sel:[0,0] op_sel_hi:[0,1]
v_pk_mul_f32 v[30:31], v[24:25], v[32:33] op_sel:[0,0] op_sel_hi:[0,1] neg_hi:[0,1]
v_pk_fma_f32 v[26:27], v[26:27], v[38:39], v[28:29] op_sel:[1,1,0] op_sel_hi:[1,0,1] neg_lo:[0,1,0]
v_pk_fma_f32 v[24:25], v[24:25], v[32:33], v[30:31] op_sel:[1,1,0] op_sel_hi:[1,0,1]
v_cvt_pk_bf16_f32 v46, v26, v27
ds_write_addtid_b32 v48 offset:2176
ds_write_addtid_b32 v49 offset:10608
v_mfma_f32_32x32x16_bf16 v[56:71], v[88:91], v[92:95], v[56:71]
v_pk_mul_f32 v[28:29], v[26:27], v[38:39] op_sel:[0,0] op_sel_hi:[0,1]
v_pk_mul_f32 v[30:31], v[24:25], v[40:41] op_sel:[0,0] op_sel_hi:[0,1] neg_hi:[0,1]
v_pk_fma_f32 v[26:27], v[26:27], v[38:39], v[28:29] op_sel:[1,1,0] op_sel_hi:[1,0,1] neg_lo:[0,1,0]
v_pk_fma_f32 v[24:25], v[24:25], v[40:41], v[30:31] op_sel:[1,1,0] op_sel_hi:[1,0,1]
v_cvt_pk_bf16_f32 v47, v26, v27
v_cvt_pk_bf16_f32 v48, v24, v25
ds_write_addtid_b32 v46 offset:2448
v_pk_mul_f32 v[28:29], v[26:27], v[38:39] op_sel:[0,0] op_sel_hi:[0,1]
v_pk_mul_f32 v[30:31], v[24:25], v[34:35] op_sel:[0,0] op_sel_hi:[0,1] neg_hi:[0,1]
v_pk_fma_f32 v[26:27], v[26:27], v[38:39], v[28:29] op_sel:[1,1,0] op_sel_hi:[1,0,1] neg_lo:[0,1,0]
v_pk_fma_f32 v[24:25], v[24:25], v[34:35], v[30:31] op_sel:[1,1,0] op_sel_hi:[1,0,1]
v_cvt_pk_bf16_f32 v49, v26, v27
v_cvt_pk_bf16_f32 v46, v24, v25
ds_write_addtid_b32 v47 offset:2720
ds_write_addtid_b32 v48 offset:10880
v_pk_mul_f32 v[28:29], v[26:27], v[38:39] op_sel:[0,0] op_sel_hi:[0,1]
v_pk_mul_f32 v[30:31], v[24:25], v[34:35] op_sel:[0,0] op_sel_hi:[0,1] neg_hi:[0,1]
v_pk_fma_f32 v[26:27], v[26:27], v[38:39], v[28:29] op_sel:[1,1,0] op_sel_hi:[1,0,1] neg_lo:[0,1,0]
v_pk_fma_f32 v[24:25], v[24:25], v[34:35], v[30:31] op_sel:[1,1,0] op_sel_hi:[1,0,1]
v_cvt_pk_bf16_f32 v47, v26, v27
v_cvt_pk_bf16_f32 v48, v24, v25
ds_write_addtid_b32 v49 offset:2992
ds_write_addtid_b32 v46 offset:11152
v_mfma_f32_32x32x16_bf16 v[56:71], v[96:99], v[100:103], v[56:71]
v_pk_mul_f32 v[28:29], v[26:27], v[38:39] op_sel:[0,0] op_sel_hi:[0,1]
v_pk_mul_f32 v[30:31], v[24:25], v[34:35] op_sel:[0,0] op_sel_hi:[0,1] neg_hi:[0,1]
v_pk_fma_f32 v[26:27], v[26:27], v[38:39], v[28:29] op_sel:[1,1,0] op_sel_hi:[1,0,1] neg_lo:[0,1,0]
v_pk_fma_f32 v[24:25], v[24:25], v[34:35], v[30:31] op_sel:[1,1,0] op_sel_hi:[1,0,1]
v_cvt_pk_bf16_f32 v49, v26, v27
v_cvt_pk_bf16_f32 v46, v24, v25
ds_write_addtid_b32 v47 offset:3264
ds_write_addtid_b32 v48 offset:11424
ds_write_addtid_b32 v48 offset:11968
v_pk_mul_f32 v[28:29], v[26:27], v[38:39] op_sel:[0,0] op_sel_hi:[0,1]
v_pk_mul_f32 v[30:31], v[24:25], v[34:35] op_sel:[0,0] op_sel_hi:[0,1] neg_hi:[0,1]
v_pk_fma_f32 v[26:27], v[26:27], v[38:39], v[28:29] op_sel:[1,1,0] op_sel_hi:[1,0,1] neg_lo:[0,1,0]
v_pk_fma_f32 v[24:25], v[24:25], v[34:35], v[30:31] op_sel:[1,1,0] op_sel_hi:[1,0,1]
v_cvt_pk_bf16_f32 v47, v26, v27
v_cvt_pk_bf16_f32 v48, v24, v25
ds_write_addtid_b32 v49 offset:3536
ds_write_addtid_b32 v46 offset:12240
v_pk_mul_f32 v[28:29], v[26:27], v[38:39] op_sel:[0,0] op_sel_hi:[0,1]
v_pk_mul_f32 v[30:31], v[24:25], v[40:41] op_sel:[0,0] op_sel_hi:[0,1] neg_hi:[0,1]
v_pk_fma_f32 v[26:27], v[26:27], v[38:39], v[28:29] op_sel:[1,1,0] op_sel_hi:[1,0,1] neg_lo:[0,1,0]
v_pk_fma_f32 v[24:25], v[24:25], v[40:41], v[30:31] op_sel:[1,1,0] op_sel_hi:[1,0,1]
v_cvt_pk_bf16_f32 v49, v26, v27
v_cvt_pk_bf16_f32 v46, v24, v25
ds_write_addtid_b32 v47 offset:3808
ds_write_addtid_b32 v48 offset:12512
v_mfma_f32_32x32x16_bf16 v[56:71], v[104:107], v[108:111], v[56:71]
v_pk_mul_f32 v[28:29], v[26:27], v[38:39] op_sel:[0,0] op_sel_hi:[0,1]
v_pk_mul_f32 v[30:31], v[24:25], v[36:37] op_sel:[0,0] op_sel_hi:[0,1] neg_hi:[0,1]
v_pk_fma_f32 v[26:27], v[26:27], v[38:39], v[28:29] op_sel:[1,1,0] op_sel_hi:[1,0,1] neg_lo:[0,1,0]
v_pk_fma_f32 v[24:25], v[24:25], v[36:37], v[30:31] op_sel:[1,1,0] op_sel_hi:[1,0,1]
v_cvt_pk_bf16_f32 v47, v26, v27
v_cvt_pk_bf16_f32 v48, v24, v25
ds_write_addtid_b32 v49 offset:4080
ds_write_addtid_b32 v46 offset:13056
v_pk_mul_f32 v[28:29], v[26:27], v[38:39] op_sel:[0,0] op_sel_hi:[0,1]
v_pk_mul_f32 v[30:31], v[24:25], v[36:37] op_sel:[0,0] op_sel_hi:[0,1] neg_hi:[0,1]
v_pk_fma_f32 v[26:27], v[26:27], v[38:39], v[28:29] op_sel:[1,1,0] op_sel_hi:[1,0,1] neg_lo:[0,1,0]
v_pk_fma_f32 v[24:25], v[24:25], v[36:37], v[30:31] op_sel:[1,1,0] op_sel_hi:[1,0,1]
v_cvt_pk_bf16_f32 v49, v26, v27
v_cvt_pk_bf16_f32 v46, v24, v25
ds_write_addtid_b32 v47 offset:4352
ds_write_addtid_b32 v48 offset:13328
ds_write_addtid_b32 v48 offset:14144
v_pk_mul_f32 v[28:29], v[26:27], v[38:39] op_sel:[0,0] op_sel_hi:[0,1]
v_pk_mul_f32 v[30:31], v[24:25], v[40:41] op_sel:[0,0] op_sel_hi:[0,1] neg_hi:[0,1]
v_pk_fma_f32 v[26:27], v[26:27], v[38:39], v[28:29] op_sel:[1,1,0] op_sel_hi:[1,0,1] neg_lo:[0,1,0]
v_pk_fma_f32 v[24:25], v[24:25], v[40:41], v[30:31] op_sel:[1,1,0] op_sel_hi:[1,0,1]
v_cvt_pk_bf16_f32 v47, v26, v27
v_cvt_pk_bf16_f32 v48, v24, v25
ds_write_addtid_b32 v49 offset:4624
ds_write_addtid_b32 v46 offset:14416
v_mfma_f32_32x32x16_bf16 v[56:71], v[112:115], v[116:119], v[56:71]
v_pk_mul_f32 v[28:29], v[26:27], v[38:39] op_sel:[0,0] op_sel_hi:[0,1]
v_pk_mul_f32 v[30:31], v[24:25], v[36:37] op_sel:[0,0] op_sel_hi:[0,1] neg_hi:[0,1]
v_pk_fma_f32 v[26:27], v[26:27], v[38:39], v[28:29] op_sel:[1,1,0] op_sel_hi:[1,0,1] neg_lo:[0,1,0]
v_pk_fma_f32 v[24:25], v[24:25], v[36:37], v[30:31] op_sel:[1,1,0] op_sel_hi:[1,0,1]
v_cvt_pk_bf16_f32 v49, v26, v27
v_cvt_pk_bf16_f32 v46, v24, v25
ds_write_addtid_b32 v47 offset:4896
ds_write_addtid_b32 v48 offset:13600
v_pk_mul_f32 v[28:29], v[26:27], v[38:39] op_sel:[0,0] op_sel_hi:[0,1]
v_pk_mul_f32 v[30:31], v[24:25], v[36:37] op_sel:[0,0] op_sel_hi:[0,1] neg_hi:[0,1]
v_pk_fma_f32 v[26:27], v[26:27], v[38:39], v[28:29] op_sel:[1,1,0] op_sel_hi:[1,0,1] neg_lo:[0,1,0]
v_pk_fma_f32 v[24:25], v[24:25], v[36:37], v[30:31] op_sel:[1,1,0] op_sel_hi:[1,0,1]
v_cvt_pk_bf16_f32 v47, v26, v27
v_cvt_pk_bf16_f32 v48, v24, v25
ds_write_addtid_b32 v49 offset:5168
ds_write_addtid_b32 v46 offset:13872
ds_write_addtid_b32 v46 offset:14688
v_pk_mul_f32 v[28:29], v[26:27], v[38:39] op_sel:[0,0] op_sel_hi:[0,1]
v_pk_mul_f32 v[30:31], v[24:25], v[40:41] op_sel:[0,0] op_sel_hi:[0,1] neg_hi:[0,1]
v_pk_fma_f32 v[26:27], v[26:27], v[38:39], v[28:29] op_sel:[1,1,0] op_sel_hi:[1,0,1] neg_lo:[0,1,0]
v_pk_fma_f32 v[24:25], v[24:25], v[40:41], v[30:31] op_sel:[1,1,0] op_sel_hi:[1,0,1]
v_cvt_pk_bf16_f32 v49, v26, v27
v_cvt_pk_bf16_f32 v46, v24, v25
ds_write_addtid_b32 v47 offset:5440
ds_write_addtid_b32 v48 offset:14960
v_mfma_f32_32x32x16_bf16 v[56:71], v[120:123], v[124:127], v[56:71]
v_pk_mul_f32 v[28:29], v[26:27], v[38:39] op_sel:[0,0] op_sel_hi:[0,1]
v_pk_mul_f32 v[30:31], v[24:25], v[38:39] op_sel:[0,0] op_sel_hi:[0,1] neg_hi:[0,1]
v_pk_fma_f32 v[26:27], v[26:27], v[38:39], v[28:29] op_sel:[1,1,0] op_sel_hi:[1,0,1] neg_lo:[0,1,0]
v_pk_fma_f32 v[24:25], v[24:25], v[38:39], v[30:31] op_sel:[1,1,0] op_sel_hi:[1,0,1]
v_cvt_pk_bf16_f32 v47, v26, v27
v_cvt_pk_bf16_f32 v48, v24, v25
ds_write_addtid_b32 v49 offset:5712
ds_write_addtid_b32 v46 offset:15232
v_pk_mul_f32 v[28:29], v[26:27], v[38:39] op_sel:[0,0] op_sel_hi:[0,1]
v_pk_mul_f32 v[30:31], v[24:25], v[40:41] op_sel:[0,0] op_sel_hi:[0,1] neg_hi:[0,1]
v_pk_fma_f32 v[26:27], v[26:27], v[38:39], v[28:29] op_sel:[1,1,0] op_sel_hi:[1,0,1] neg_lo:[0,1,0]
v_pk_fma_f32 v[24:25], v[24:25], v[40:41], v[30:31] op_sel:[1,1,0] op_sel_hi:[1,0,1]
v_cvt_pk_bf16_f32 v49, v26, v27
v_cvt_pk_bf16_f32 v46, v24, v25
ds_write_addtid_b32 v47 offset:5984
ds_write_addtid_b32 v48 offset:16320
v_pk_mul_f32 v[28:29], v[26:27], v[38:39] op_sel:[0,0] op_sel_hi:[0,1]
v_pk_mul_f32 v[30:31], v[24:25], v[38:39] op_sel:[0,0] op_sel_hi:[0,1] neg_hi:[0,1]
v_pk_fma_f32 v[26:27], v[26:27], v[38:39], v[28:29] op_sel:[1,1,0] op_sel_hi:[1,0,1] neg_lo:[0,1,0]
v_pk_fma_f32 v[24:25], v[24:25], v[38:39], v[30:31] op_sel:[1,1,0] op_sel_hi:[1,0,1]
v_cvt_pk_bf16_f32 v47, v26, v27
v_cvt_pk_bf16_f32 v48, v24, v25
ds_write_addtid_b32 v49 offset:6256
ds_write_addtid_b32 v46 offset:15504
v_mfma_f32_32x32x16_bf16 v[56:71], v[128:131], v[132:135], v[56:71]
v_pk_mul_f32 v[28:29], v[26:27], v[38:39] op_sel:[0,0] op_sel_hi:[0,1]
v_pk_mul_f32 v[30:31], v[24:25], v[40:41] op_sel:[0,0] op_sel_hi:[0,1] neg_hi:[0,1]
v_pk_fma_f32 v[26:27], v[26:27], v[38:39], v[28:29] op_sel:[1,1,0] op_sel_hi:[1,0,1] neg_lo:[0,1,0]
v_pk_fma_f32 v[24:25], v[24:25], v[40:41], v[30:31] op_sel:[1,1,0] op_sel_hi:[1,0,1]
v_cvt_pk_bf16_f32 v49, v26, v27
v_cvt_pk_bf16_f32 v46, v24, v25
ds_write_addtid_b32 v47 offset:6528
ds_write_addtid_b32 v48 offset:16592
v_pk_mul_f32 v[28:29], v[26:27], v[38:39] op_sel:[0,0] op_sel_hi:[0,1]
v_pk_mul_f32 v[30:31], v[24:25], v[38:39] op_sel:[0,0] op_sel_hi:[0,1] neg_hi:[0,1]
v_pk_fma_f32 v[26:27], v[26:27], v[38:39], v[28:29] op_sel:[1,1,0] op_sel_hi:[1,0,1] neg_lo:[0,1,0]
v_pk_fma_f32 v[24:25], v[24:25], v[38:39], v[30:31] op_sel:[1,1,0] op_sel_hi:[1,0,1]
v_cvt_pk_bf16_f32 v47, v26, v27
v_cvt_pk_bf16_f32 v48, v24, v25
ds_write_addtid_b32 v49 offset:6800
ds_write_addtid_b32 v46 offset:15776
v_pk_mul_f32 v[28:29], v[26:27], v[38:39] op_sel:[0,0] op_sel_hi:[0,1]
v_pk_mul_f32 v[30:31], v[24:25], v[40:41] op_sel:[0,0] op_sel_hi:[0,1] neg_hi:[0,1]
v_pk_fma_f32 v[26:27], v[26:27], v[38:39], v[28:29] op_sel:[1,1,0] op_sel_hi:[1,0,1] neg_lo:[0,1,0]
v_pk_fma_f32 v[24:25], v[24:25], v[40:41], v[30:31] op_sel:[1,1,0] op_sel_hi:[1,0,1]
v_cvt_pk_bf16_f32 v49, v26, v27
v_cvt_pk_bf16_f32 v46, v24, v25
ds_write_addtid_b32 v47 offset:7072
ds_write_addtid_b32 v48 offset:16864
v_pk_mul_f32 v[28:29], v[26:27], v[38:39] op_sel:[0,0] op_sel_hi:[0,1]
v_pk_mul_f32 v[30:31], v[24:25], v[38:39] op_sel:[0,0] op_sel_hi:[0,1] neg_hi:[0,1]
v_pk_fma_f32 v[26:27], v[26:27], v[38:39], v[28:29] op_sel:[1,1,0] op_sel_hi:[1,0,1] neg_lo:[0,1,0]
v_pk_fma_f32 v[24:25], v[24:25], v[38:39], v[30:31] op_sel:[1,1,0] op_sel_hi:[1,0,1]
v_cvt_pk_bf16_f32 v47, v26, v27
v_cvt_pk_bf16_f32 v48, v24, v25
ds_write_addtid_b32 v49 offset:7344
ds_write_addtid_b32 v46 offset:16048
v_pk_mul_f32 v[28:29], v[26:27], v[38:39] op_sel:[0,0] op_sel_hi:[0,1]
v_pk_fma_f32 v[26:27], v[26:27], v[38:39], v[28:29] op_sel:[1,1,0] op_sel_hi:[1,0,1] neg_lo:[0,1,0]
v_cvt_pk_bf16_f32 v49, v26, v27
ds_write_addtid_b32 v47 offset:7616
ds_write_addtid_b32 v48 offset:17136
v_pk_mul_f32 v[28:29], v[26:27], v[38:39] op_sel:[0,0] op_sel_hi:[0,1]
v_pk_fma_f32 v[26:27], v[26:27], v[38:39], v[28:29] op_sel:[1,1,0] op_sel_hi:[1,0,1] neg_lo:[0,1,0]
v_cvt_pk_bf16_f32 v46, v26, v27
ds_write_addtid_b32 v49 offset:7888
v_pk_mul_f32 v[28:29], v[26:27], v[38:39] op_sel:[0,0] op_sel_hi:[0,1]
v_pk_fma_f32 v[26:27], v[26:27], v[38:39], v[28:29] op_sel:[1,1,0] op_sel_hi:[1,0,1] neg_lo:[0,1,0]
v_cvt_pk_bf16_f32 v47, v26, v27
ds_write_addtid_b32 v46 offset:8160
ds_write_addtid_b32 v47 offset:8432
s_waitcnt lgkmcnt(0)
ds_read_b128 v[72:75], v51 offset:0
ds_read_b128 v[76:79], v52 offset:0
ds_read_b128 v[80:83], v51 offset:32
ds_read_b128 v[84:87], v52 offset:32
ds_read_b128 v[88:91], v51 offset:64
ds_read_b128 v[92:95], v52 offset:64
ds_read_b128 v[96:99], v51 offset:96
ds_read_b128 v[100:103], v52 offset:96
ds_read_b128 v[104:107], v51 offset:128
ds_read_b128 v[108:111], v52 offset:128
ds_read_b128 v[112:115], v51 offset:160
ds_read_b128 v[116:119], v52 offset:160
ds_read_b128 v[120:123], v51 offset:192
ds_read_b128 v[124:127], v52 offset:192
ds_read_b128 v[128:131], v51 offset:224
ds_read_b128 v[132:135], v52 offset:224
s_waitcnt lgkmcnt(0)
v_mfma_f32_32x32x16_bf16 v[56:71], v[72:75], v[76:79], v[56:71]
v_mfma_f32_32x32x16_bf16 v[56:71], v[80:83], v[84:87], v[56:71]
v_mfma_f32_32x32x16_bf16 v[56:71], v[88:91], v[92:95], v[56:71]
v_mfma_f32_32x32x16_bf16 v[56:71], v[96:99], v[100:103], v[56:71]
v_mfma_f32_32x32x16_bf16 v[56:71], v[104:107], v[108:111], v[56:71]
v_mfma_f32_32x32x16_bf16 v[56:71], v[112:115], v[116:119], v[56:71]
v_mfma_f32_32x32x16_bf16 v[56:71], v[120:123], v[124:127], v[56:71]
v_mfma_f32_32x32x16_bf16 v[56:71], v[128:131], v[132:135], v[56:71]
v_lshlrev_b32 v43, 4, v1
s_lshl_b32 s56, s54, 11
s_add_u32 s56, s56, 13762560
s_mov_b64 exec, 1
s_nop 7
v_add_f32 v56, s59, v56
s_mov_b64 exec, -1
s_mov_b32 s65, s55
v_mov_b32 v28, 0
v_mov_b32 v29, 0
v_mov_b32 v30, 0
v_mov_b32 v31, 0
v_lshlrev_b32 v44, 4, v1
v_add_u32 v44, s65, v44
v_and_b32 v42, 31, v1
v_lshlrev_b32 v42, 4, v42
v_lshrrev_b32 v43, 5, v1
v_lshlrev_b32 v43, 3, v43
v_add_u32 v42, v42, v43
v_add_u32 v42, s65, v42
v_cmp_lt_u32 vcc, 31, v1
s_mov_b32 exec_hi, 0
ds_write_b128 v44, v[28:31]
ds_write_b128 v44, v[28:31] offset:4576
s_mov_b64 exec, -1
v_cndmask_b32 v44, v64, v65, vcc
v_cndmask_b32 v45, v66, v67, vcc
v_cvt_pk_bf16_f32 v72, v56, v57
v_cvt_pk_bf16_f32 v73, v58, v59
v_cvt_pk_bf16_f32 v74, v57, v58
v_cvt_pk_bf16_f32 v76, v60, v60
v_cvt_pk_bf16_f32 v77, v61, v62
v_cvt_pk_bf16_f32 v78, v60, v61
v_cvt_pk_bf16_f32 v80, v64, v64
v_cvt_pk_bf16_f32 v81, v44, v65
v_cvt_pk_bf16_f32 v82, v64, v44
v_cvt_pk_bf16_f32 v84, v66, v66
v_cvt_pk_bf16_f32 v85, v45, v67
v_cvt_pk_bf16_f32 v86, v66, v45
v_cvt_pk_bf16_f32 v88, v68, v68
v_mov_b32 v89, v88
v_cvt_pk_bf16_f32 v90, v69, v69
v_mov_b32 v91, v90
v_cvt_pk_bf16_f32 v92, v70, v70
v_mov_b32 v93, v92
v_cvt_pk_bf16_f32 v94, v71, v71
v_mov_b32 v95, v94
ds_write_b64 v42, v[72:73] offset:5024
ds_write_b16 v42, v72 offset:450
ds_write_b32 v42, v74 offset:452
ds_write_b16_d16_hi v42, v73 offset:456
ds_write_b64 v42, v[76:77] offset:5536
ds_write_b16 v42, v76 offset:962
ds_write_b32 v42, v78 offset:964
ds_write_b16_d16_hi v42, v77 offset:968
ds_write_b64 v42, v[80:81] offset:6048
ds_write_b16 v42, v80 offset:1474
ds_write_b32 v42, v82 offset:1476
ds_write_b16_d16_hi v42, v81 offset:1480
ds_write_b64 v42, v[84:85] offset:6560
ds_write_b16 v42, v84 offset:1986
ds_write_b32 v42, v86 offset:1988
ds_write_b16_d16_hi v42, v85 offset:1992
ds_write_b64 v42, v[88:89] offset:7072
ds_write_b16 v42, v88 offset:2498
ds_write_b32 v42, v88 offset:2500
ds_write_b16 v42, v88 offset:2504
ds_write_b64 v42, v[90:91] offset:7584
ds_write_b16 v42, v90 offset:3010
ds_write_b32 v42, v90 offset:3012
ds_write_b16 v42, v90 offset:3016
ds_write_b64 v42, v[92:93] offset:8096
ds_write_b16 v42, v92 offset:3522
ds_write_b32 v42, v92 offset:3524
ds_write_b16 v42, v92 offset:3528
ds_write_b64 v42, v[94:95] offset:8608
ds_write_b16 v42, v94 offset:4034
ds_write_b32 v42, v94 offset:4036
ds_write_b16 v42, v94 offset:4040
s_mov_b64 exec, 0x55555555
ds_write_b16 v42, v88 offset:7080
ds_write_b16 v42, v88 offset:2506
ds_write_b16 v42, v90 offset:7592
ds_write_b16 v42, v90 offset:3018
ds_write_b16 v42, v92 offset:8104
ds_write_b16 v42, v92 offset:3530
ds_write_b16 v42, v94 offset:8616
ds_write_b16 v42, v94 offset:4042
s_mov_b64 exec, -1
s_branch L_A_stage
L_A_aux:
s_setprio 3
v_mov_b32 v204, 0
s_cmp_lg_u32 s53, 0
s_cbranch_scc1 L_noep_1
s_memrealtime s[56:57]
s_waitcnt lgkmcnt(0)
s_or_b32 s56, s56, 1
v_mov_b32 v200, s56
s_mov_b64 exec, 1
buffer_store_dword v200, v204, s[48:51], 0 offen sc0 sc1
s_mov_b64 exec, -1
L_noep_1:
s_and_b32 s72, s53, 3
s_lshl_b32 s72, s72, 2
s_lshr_b32 s73, s53, 6
s_add_u32 s72, s72, s73
s_bfe_u32 s73, s53, 0x10002
s_lshl_b32 s73, s73, 3
s_bfe_u32 s56, s53, 0x30003
s_add_u32 s73, s73, s56
s_lshl_b32 s77, s72, 4
s_add_u32 s77, s77, s73
s_mul_i32 s56, s72, 163840
s_mul_i32 s57, s73, 80
s_add_u32 s56, s56, s57
v_add_u32 v200, 0, v1
v_mul_u32_u24 v201, 10923, v200
v_lshrrev_b32 v201, 16, v201
v_mul_u32_u24 v202, 6, v201
v_sub_u32 v202, v200, v202
v_lshlrev_b32 v202, 4, v202
v_mul_u32_u24 v201, 1280, v201
v_add_u32 v196, v201, v202
v_add_u32 v200, 64, v1
v_mul_u32_u24 v201, 10923, v200
v_lshrrev_b32 v201, 16, v201
v_mul_u32_u24 v202, 6, v201
v_sub_u32 v202, v200, v202
v_lshlrev_b32 v202, 4, v202
v_mul_u32_u24 v201, 1280, v201
v_add_u32 v197, v201, v202
v_add_u32 v200, 128, v1
v_mul_u32_u24 v201, 10923, v200
v_lshrrev_b32 v201, 16, v201
v_mul_u32_u24 v202, 6, v201
v_sub_u32 v202, v200, v202
v_lshlrev_b32 v202, 4, v202
v_mul_u32_u24 v201, 1280, v201
v_add_u32 v198, v201, v202
s_mov_b32 m0, 52224
s_nop 0
buffer_load_dwordx4 v196, s[40:43], s56 offen lds
s_mov_b32 m0, 53248
s_nop 0
buffer_load_dwordx4 v197, s[40:43], s56 offen lds
s_mov_b32 m0, 54272
s_nop 0
buffer_load_dwordx4 v198, s[40:43], s56 offen lds
s_add_u32 s56, s56, 40960
s_mov_b32 m0, 55296
s_nop 0
buffer_load_dwordx4 v196, s[40:43], s56 offen lds
s_mov_b32 m0, 56320
s_nop 0
buffer_load_dwordx4 v197, s[40:43], s56 offen lds
s_mov_b32 m0, 57344
s_nop 0
buffer_load_dwordx4 v198, s[40:43], s56 offen lds
s_add_u32 s56, s56, 40960
s_mov_b32 m0, 58368
s_nop 0
buffer_load_dwordx4 v196, s[40:43], s56 offen lds
s_mov_b32 m0, 59392
s_nop 0
buffer_load_dwordx4 v197, s[40:43], s56 offen lds
s_mov_b32 m0, 60416
s_nop 0
buffer_load_dwordx4 v198, s[40:43], s56 offen lds
s_add_u32 s56, s56, 40960
s_mov_b32 m0, 61440
s_nop 0
buffer_load_dwordx4 v196, s[40:43], s56 offen lds
s_mov_b32 m0, 62464
s_nop 0
buffer_load_dwordx4 v197, s[40:43], s56 offen lds
s_mov_b32 m0, 63488
s_nop 0
buffer_load_dwordx4 v198, s[40:43], s56 offen lds
v_mul_u32_u24 v200, 20, v1
s_mul_i32 s56, s77, 10240
buffer_load_dwordx4 v[2:5], v200, s[40:43], s56 offen
buffer_load_dword v34, v200, s[40:43], s56 offen offset:16
s_add_u32 s56, s56, 1280
buffer_load_dwordx4 v[6:9], v200, s[40:43], s56 offen
buffer_load_dword v35, v200, s[40:43], s56 offen offset:16
s_add_u32 s56, s56, 1280
buffer_load_dwordx4 v[10:13], v200, s[40:43], s56 offen
buffer_load_dword v36, v200, s[40:43], s56 offen offset:16
s_add_u32 s56, s56, 1280
buffer_load_dwordx4 v[14:17], v200, s[40:43], s56 offen
buffer_load_dword v37, v200, s[40:43], s56 offen offset:16
s_add_u32 s56, s56, 1280
buffer_load_dwordx4 v[18:21], v200, s[40:43], s56 offen
buffer_load_dword v38, v200, s[40:43], s56 offen offset:16
s_add_u32 s56, s56, 1280
buffer_load_dwordx4 v[22:25], v200, s[40:43], s56 offen
buffer_load_dword v39, v200, s[40:43], s56 offen offset:16
s_add_u32 s56, s56, 1280
buffer_load_dwordx4 v[26:29], v200, s[40:43], s56 offen
buffer_load_dword v40, v200, s[40:43], s56 offen offset:16
s_add_u32 s56, s56, 1280
buffer_load_dwordx4 v[30:33], v200, s[40:43], s56 offen
buffer_load_dword v41, v200, s[40:43], s56 offen offset:16
buffer_load_dword v203, v204, s[48:51], 0 offen sc0 sc1
v_lshrrev_b32 v200, 2, v1
v_mul_u32_u24 v200, 96, v200
v_and_b32 v201, 3, v1
v_lshlrev_b32 v202, 3, v201
v_add_u32 v200, v200, v202
v_add_u32 v200, 52224, v200
v_and_b32 v196, 15, v1
v_lshlrev_b32 v196, 6, v196
v_lshrrev_b32 v197, 4, v1
v_lshlrev_b32 v197, 3, v197
v_add_u32 v196, v196, v197
v_add_u32 v196, 52224, v196
v_lshlrev_b32 v197, 4, v1
v_add_u32 v197, 52224, v197
v_lshrrev_b32 v198, 2, v1
v_lshlrev_b32 v198, 12, v198
v_lshlrev_b32 v201, 4, v201
v_add_u32 v198, v198, v201
s_mul_i32 s56, s73, 163840
s_lshl_b32 s57, s72, 8
s_add_u32 s56, s56, s57
s_add_u32 s56, s56, 0
s_add_u32 s57, s56, 65536
s_add_u32 s58, s56, 131072
s_waitcnt vmcnt(17)
ds_read_b64_tr_b16 v[146:147], v200 offset:0
ds_read_b64_tr_b16 v[148:149], v200 offset:32
ds_read_b64_tr_b16 v[150:151], v200 offset:64
ds_read_b64_tr_b16 v[152:153], v200 offset:1536
ds_read_b64_tr_b16 v[154:155], v200 offset:1568
ds_read_b64_tr_b16 v[156:157], v200 offset:1600
ds_read_b64_tr_b16 v[158:159], v200 offset:3072
ds_read_b64_tr_b16 v[160:161], v200 offset:3104
ds_read_b64_tr_b16 v[162:163], v200 offset:3136
ds_read_b64_tr_b16 v[164:165], v200 offset:4608
ds_read_b64_tr_b16 v[166:167], v200 offset:4640
ds_read_b64_tr_b16 v[168:169], v200 offset:4672
s_waitcnt lgkmcnt(0)
ds_write_b64 v196, v[146:147] offset:0
ds_write_b64 v196, v[148:149] offset:1024
ds_write_b64 v196, v[150:151] offset:2048
ds_write_b64 v196, v[152:153] offset:32
ds_write_b64 v196, v[154:155] offset:1056
ds_write_b64 v196, v[156:157] offset:2080
ds_write_b64 v196, v[158:159] offset:3072
ds_write_b64 v196, v[160:161] offset:4096
ds_write_b64 v196, v[162:163] offset:5120
ds_write_b64 v196, v[164:165] offset:3104
ds_write_b64 v196, v[166:167] offset:4128
ds_write_b64 v196, v[168:169] offset:5152
ds_read_b64_tr_b16 v[146:147], v200 offset:6144
ds_read_b64_tr_b16 v[148:149], v200 offset:6176
ds_read_b64_tr_b16 v[150:151], v200 offset:6208
ds_read_b64_tr_b16 v[152:153], v200 offset:7680
ds_read_b64_tr_b16 v[154:155], v200 offset:7712
ds_read_b64_tr_b16 v[156:157], v200 offset:7744
ds_read_b64_tr_b16 v[158:159], v200 offset:9216
ds_read_b64_tr_b16 v[160:161], v200 offset:9248
ds_read_b64_tr_b16 v[162:163], v200 offset:9280
ds_read_b64_tr_b16 v[164:165], v200 offset:10752
ds_read_b64_tr_b16 v[166:167], v200 offset:10784
ds_read_b64_tr_b16 v[168:169], v200 offset:10816
s_waitcnt lgkmcnt(0)
ds_write_b64 v196, v[146:147] offset:6144
ds_write_b64 v196, v[148:149] offset:7168
ds_write_b64 v196, v[150:151] offset:8192
ds_write_b64 v196, v[152:153] offset:6176
ds_write_b64 v196, v[154:155] offset:7200
ds_write_b64 v196, v[156:157] offset:8224
ds_write_b64 v196, v[158:159] offset:9216
ds_write_b64 v196, v[160:161] offset:10240
ds_write_b64 v196, v[162:163] offset:11264
ds_write_b64 v196, v[164:165] offset:9248
ds_write_b64 v196, v[166:167] offset:10272
ds_write_b64 v196, v[168:169] offset:11296
s_waitcnt lgkmcnt(0)
ds_read_b128 v[146:149], v197 offset:0
ds_read_b128 v[150:153], v197 offset:1024
ds_read_b128 v[154:157], v197 offset:2048
ds_read_b128 v[158:161], v197 offset:3072
ds_read_b128 v[162:165], v197 offset:4096
ds_read_b128 v[166:169], v197 offset:5120
ds_read_b128 v[170:173], v197 offset:6144
ds_read_b128 v[174:177], v197 offset:7168
ds_read_b128 v[178:181], v197 offset:8192
ds_read_b128 v[182:185], v197 offset:9216
ds_read_b128 v[186:189], v197 offset:10240
ds_read_b128 v[190:193], v197 offset:11264
s_waitcnt vmcnt(0)
s_waitcnt lgkmcnt(9)
buffer_store_dwordx4 v[146:149], v198, s[36:39], s56 offen offset:0 sc0 sc1
buffer_store_dwordx4 v[150:153], v198, s[36:39], s57 offen offset:0 sc0 sc1
s_mov_b32 exec_hi, 0
buffer_store_dwordx4 v[154:157], v198, s[36:39], s58 offen offset:0 sc0 sc1
s_mov_b64 exec, -1
s_waitcnt lgkmcnt(6)
buffer_store_dwordx4 v[158:161], v198, s[36:39], s56 offen offset:64 sc0 sc1
buffer_store_dwordx4 v[162:165], v198, s[36:39], s57 offen offset:64 sc0 sc1
s_mov_b32 exec_hi, 0
buffer_store_dwordx4 v[166:169], v198, s[36:39], s58 offen offset:64 sc0 sc1
s_mov_b64 exec, -1
s_waitcnt lgkmcnt(3)
buffer_store_dwordx4 v[170:173], v198, s[36:39], s56 offen offset:128 sc0 sc1
buffer_store_dwordx4 v[174:177], v198, s[36:39], s57 offen offset:128 sc0 sc1
s_mov_b32 exec_hi, 0
buffer_store_dwordx4 v[178:181], v198, s[36:39], s58 offen offset:128 sc0 sc1
s_mov_b64 exec, -1
s_waitcnt lgkmcnt(0)
buffer_store_dwordx4 v[182:185], v198, s[36:39], s56 offen offset:192 sc0 sc1
buffer_store_dwordx4 v[186:189], v198, s[36:39], s57 offen offset:192 sc0 sc1
s_mov_b32 exec_hi, 0
buffer_store_dwordx4 v[190:193], v198, s[36:39], s58 offen offset:192 sc0 sc1
s_mov_b64 exec, -1
v_add_u32 v200, 0, v1
v_mul_u32_u24 v201, 6554, v200
v_lshrrev_b32 v201, 16, v201
v_mul_u32_u24 v202, 10, v201
v_sub_u32 v202, v200, v202
v_lshlrev_b32 v202, 4, v202
v_mul_u32_u24 v201, 1280, v201
v_add_u32 v206, v201, v202
v_add_u32 v200, 64, v1
v_mul_u32_u24 v201, 6554, v200
v_lshrrev_b32 v201, 16, v201
v_mul_u32_u24 v202, 10, v201
v_sub_u32 v202, v200, v202
v_lshlrev_b32 v202, 4, v202
v_mul_u32_u24 v201, 1280, v201
v_add_u32 v207, v201, v202
v_add_u32 v200, 128, v1
v_mul_u32_u24 v201, 6554, v200
v_lshrrev_b32 v201, 16, v201
v_mul_u32_u24 v202, 10, v201
v_sub_u32 v202, v200, v202
v_lshlrev_b32 v202, 4, v202
v_mul_u32_u24 v201, 1280, v201
v_add_u32 v208, v201, v202
v_add_u32 v200, 192, v1
v_mul_u32_u24 v201, 6554, v200
v_lshrrev_b32 v201, 16, v201
v_mul_u32_u24 v202, 10, v201
v_sub_u32 v202, v200, v202
v_lshlrev_b32 v202, 4, v202
v_mul_u32_u24 v201, 1280, v201
v_add_u32 v209, v201, v202
v_add_u32 v200, 256, v1
v_mul_u32_u24 v201, 6554, v200
v_lshrrev_b32 v201, 16, v201
v_mul_u32_u24 v202, 10, v201
v_sub_u32 v202, v200, v202
v_lshlrev_b32 v202, 4, v202
v_mul_u32_u24 v201, 1280, v201
v_add_u32 v210, v201, v202
s_add_u32 s57, s53, 0
s_lshr_b32 s58, s57, 3
s_and_b32 s59, s57, 7
s_mul_i32 s60, s58, 40960
s_mul_i32 s61, s59, 160
s_add_u32 s60, s60, s61
s_mul_i32 s59, s59, 48
s_add_u32 s68, s59, s58
s_mov_b32 m0, 64512
s_nop 0
buffer_load_dwordx4 v206, s[44:47], s60 offen lds
s_mov_b32 m0, 65536
s_nop 0
buffer_load_dwordx4 v207, s[44:47], s60 offen lds
s_mov_b32 m0, 66560
s_nop 0
buffer_load_dwordx4 v208, s[44:47], s60 offen lds
s_mov_b32 m0, 67584
s_nop 0
buffer_load_dwordx4 v209, s[44:47], s60 offen lds
s_mov_b32 m0, 68608
s_nop 0
buffer_load_dwordx4 v210, s[44:47], s60 offen lds
s_cmp_lt_u32 s53, 128
s_cbranch_scc1 L_w1u_2
s_add_u32 s57, s53, 128
s_lshr_b32 s58, s57, 3
s_and_b32 s59, s57, 7
s_mul_i32 s60, s58, 40960
s_mul_i32 s61, s59, 160
s_add_u32 s60, s60, s61
s_mul_i32 s59, s59, 48
s_add_u32 s69, s59, s58
s_mov_b32 m0, 69632
s_nop 0
buffer_load_dwordx4 v206, s[44:47], s60 offen lds
s_mov_b32 m0, 70656
s_nop 0
buffer_load_dwordx4 v207, s[44:47], s60 offen lds
s_mov_b32 m0, 71680
s_nop 0
buffer_load_dwordx4 v208, s[44:47], s60 offen lds
s_mov_b32 m0, 72704
s_nop 0
buffer_load_dwordx4 v209, s[44:47], s60 offen lds
s_mov_b32 m0, 73728
s_nop 0
buffer_load_dwordx4 v210, s[44:47], s60 offen lds
L_w1u_2:
v_lshlrev_b32 v42, 16, v2
v_and_b32 v43, 0xffff0000, v2
v_lshlrev_b32 v44, 16, v3
v_and_b32 v45, 0xffff0000, v3
v_lshlrev_b32 v46, 16, v4
v_and_b32 v47, 0xffff0000, v4
v_lshlrev_b32 v48, 16, v5
v_and_b32 v49, 0xffff0000, v5
v_lshlrev_b32 v50, 16, v34
v_and_b32 v51, 0xffff0000, v34
v_lshlrev_b32 v52, 16, v6
v_and_b32 v53, 0xffff0000, v6
v_lshlrev_b32 v54, 16, v7
v_and_b32 v55, 0xffff0000, v7
v_lshlrev_b32 v56, 16, v8
v_and_b32 v57, 0xffff0000, v8
v_lshlrev_b32 v58, 16, v9
v_and_b32 v59, 0xffff0000, v9
v_lshlrev_b32 v60, 16, v35
v_and_b32 v61, 0xffff0000, v35
v_lshlrev_b32 v62, 16, v10
v_and_b32 v63, 0xffff0000, v10
v_lshlrev_b32 v64, 16, v11
v_and_b32 v65, 0xffff0000, v11
v_lshlrev_b32 v66, 16, v12
v_and_b32 v67, 0xffff0000, v12
v_lshlrev_b32 v68, 16, v13
v_and_b32 v69, 0xffff0000, v13
v_lshlrev_b32 v70, 16, v36
v_and_b32 v71, 0xffff0000, v36
v_lshlrev_b32 v72, 16, v14
v_and_b32 v73, 0xffff0000, v14
v_lshlrev_b32 v74, 16, v15
v_and_b32 v75, 0xffff0000, v15
v_lshlrev_b32 v76, 16, v16
v_and_b32 v77, 0xffff0000, v16
v_lshlrev_b32 v78, 16, v17
v_and_b32 v79, 0xffff0000, v17
v_lshlrev_b32 v80, 16, v37
v_and_b32 v81, 0xffff0000, v37
v_lshlrev_b32 v82, 16, v18
v_and_b32 v83, 0xffff0000, v18
v_lshlrev_b32 v84, 16, v19
v_and_b32 v85, 0xffff0000, v19
v_lshlrev_b32 v86, 16, v20
v_and_b32 v87, 0xffff0000, v20
v_lshlrev_b32 v88, 16, v21
v_and_b32 v89, 0xffff0000, v21
v_lshlrev_b32 v90, 16, v38
v_and_b32 v91, 0xffff0000, v38
v_lshlrev_b32 v92, 16, v22
v_and_b32 v93, 0xffff0000, v22
v_lshlrev_b32 v94, 16, v23
v_and_b32 v95, 0xffff0000, v23
v_lshlrev_b32 v96, 16, v24
v_and_b32 v97, 0xffff0000, v24
v_lshlrev_b32 v98, 16, v25
v_and_b32 v99, 0xffff0000, v25
v_lshlrev_b32 v100, 16, v39
v_and_b32 v101, 0xffff0000, v39
v_lshlrev_b32 v102, 16, v26
v_and_b32 v103, 0xffff0000, v26
v_lshlrev_b32 v104, 16, v27
v_and_b32 v105, 0xffff0000, v27
v_lshlrev_b32 v106, 16, v28
v_and_b32 v107, 0xffff0000, v28
v_lshlrev_b32 v108, 16, v29
v_and_b32 v109, 0xffff0000, v29
v_lshlrev_b32 v110, 16, v40
v_and_b32 v111, 0xffff0000, v40
v_lshlrev_b32 v112, 16, v30
v_and_b32 v113, 0xffff0000, v30
v_lshlrev_b32 v114, 16, v31
v_and_b32 v115, 0xffff0000, v31
v_lshlrev_b32 v116, 16, v32
v_and_b32 v117, 0xffff0000, v32
v_lshlrev_b32 v118, 16, v33
v_and_b32 v119, 0xffff0000, v33
v_lshlrev_b32 v120, 16, v41
v_and_b32 v121, 0xffff0000, v41
v_pk_add_f32 v[130:131], v[42:43], v[44:45]
v_pk_add_f32 v[132:133], v[52:53], v[54:55]
v_pk_add_f32 v[134:135], v[62:63], v[64:65]
v_pk_add_f32 v[136:137], v[72:73], v[74:75]
v_pk_add_f32 v[138:139], v[82:83], v[84:85]
v_pk_add_f32 v[140:141], v[92:93], v[94:95]
v_pk_add_f32 v[142:143], v[102:103], v[104:105]
v_pk_add_f32 v[144:145], v[112:113], v[114:115]
v_pk_add_f32 v[130:131], v[130:131], v[46:47]
v_pk_add_f32 v[132:133], v[132:133], v[56:57]
v_pk_add_f32 v[134:135], v[134:135], v[66:67]
v_pk_add_f32 v[136:137], v[136:137], v[76:77]
v_pk_add_f32 v[138:139], v[138:139], v[86:87]
v_pk_add_f32 v[140:141], v[140:141], v[96:97]
v_pk_add_f32 v[142:143], v[142:143], v[106:107]
v_pk_add_f32 v[144:145], v[144:145], v[116:117]
v_pk_add_f32 v[130:131], v[130:131], v[48:49]
v_pk_add_f32 v[132:133], v[132:133], v[58:59]
v_pk_add_f32 v[134:135], v[134:135], v[68:69]
v_pk_add_f32 v[136:137], v[136:137], v[78:79]
v_pk_add_f32 v[138:139], v[138:139], v[88:89]
v_pk_add_f32 v[140:141], v[140:141], v[98:99]
v_pk_add_f32 v[142:143], v[142:143], v[108:109]
v_pk_add_f32 v[144:145], v[144:145], v[118:119]
v_pk_add_f32 v[130:131], v[130:131], v[50:51]
v_pk_add_f32 v[132:133], v[132:133], v[60:61]
v_pk_add_f32 v[134:135], v[134:135], v[70:71]
v_pk_add_f32 v[136:137], v[136:137], v[80:81]
v_pk_add_f32 v[138:139], v[138:139], v[90:91]
v_pk_add_f32 v[140:141], v[140:141], v[100:101]
v_pk_add_f32 v[142:143], v[142:143], v[110:111]
v_pk_add_f32 v[144:145], v[144:145], v[120:121]
v_add_f32 v122, v130, v131
v_add_f32 v123, v132, v133
v_add_f32 v124, v134, v135
v_add_f32 v125, v136, v137
v_add_f32 v126, v138, v139
v_add_f32 v127, v140, v141
v_add_f32 v128, v142, v143
v_add_f32 v129, v144, v145
v_add_f32_dpp v122, v122, v122 row_shr:1 row_mask:0xf bank_mask:0xf bound_ctrl:1
v_add_f32_dpp v123, v123, v123 row_shr:1 row_mask:0xf bank_mask:0xf bound_ctrl:1
v_add_f32_dpp v124, v124, v124 row_shr:1 row_mask:0xf bank_mask:0xf bound_ctrl:1
v_add_f32_dpp v125, v125, v125 row_shr:1 row_mask:0xf bank_mask:0xf bound_ctrl:1
v_add_f32_dpp v126, v126, v126 row_shr:1 row_mask:0xf bank_mask:0xf bound_ctrl:1
v_add_f32_dpp v127, v127, v127 row_shr:1 row_mask:0xf bank_mask:0xf bound_ctrl:1
v_add_f32_dpp v128, v128, v128 row_shr:1 row_mask:0xf bank_mask:0xf bound_ctrl:1
v_add_f32_dpp v129, v129, v129 row_shr:1 row_mask:0xf bank_mask:0xf bound_ctrl:1
v_add_f32_dpp v122, v122, v122 row_shr:2 row_mask:0xf bank_mask:0xf bound_ctrl:1
v_add_f32_dpp v123, v123, v123 row_shr:2 row_mask:0xf bank_mask:0xf bound_ctrl:1
v_add_f32_dpp v124, v124, v124 row_shr:2 row_mask:0xf bank_mask:0xf bound_ctrl:1
v_add_f32_dpp v125, v125, v125 row_shr:2 row_mask:0xf bank_mask:0xf bound_ctrl:1
v_add_f32_dpp v126, v126, v126 row_shr:2 row_mask:0xf bank_mask:0xf bound_ctrl:1
v_add_f32_dpp v127, v127, v127 row_shr:2 row_mask:0xf bank_mask:0xf bound_ctrl:1
v_add_f32_dpp v128, v128, v128 row_shr:2 row_mask:0xf bank_mask:0xf bound_ctrl:1
v_add_f32_dpp v129, v129, v129 row_shr:2 row_mask:0xf bank_mask:0xf bound_ctrl:1
v_add_f32_dpp v122, v122, v122 row_shr:4 row_mask:0xf bank_mask:0xf bound_ctrl:1
v_add_f32_dpp v123, v123, v123 row_shr:4 row_mask:0xf bank_mask:0xf bound_ctrl:1
v_add_f32_dpp v124, v124, v124 row_shr:4 row_mask:0xf bank_mask:0xf bound_ctrl:1
v_add_f32_dpp v125, v125, v125 row_shr:4 row_mask:0xf bank_mask:0xf bound_ctrl:1
v_add_f32_dpp v126, v126, v126 row_shr:4 row_mask:0xf bank_mask:0xf bound_ctrl:1
v_add_f32_dpp v127, v127, v127 row_shr:4 row_mask:0xf bank_mask:0xf bound_ctrl:1
v_add_f32_dpp v128, v128, v128 row_shr:4 row_mask:0xf bank_mask:0xf bound_ctrl:1
v_add_f32_dpp v129, v129, v129 row_shr:4 row_mask:0xf bank_mask:0xf bound_ctrl:1
v_add_f32_dpp v122, v122, v122 row_shr:8 row_mask:0xf bank_mask:0xf bound_ctrl:1
v_add_f32_dpp v123, v123, v123 row_shr:8 row_mask:0xf bank_mask:0xf bound_ctrl:1
v_add_f32_dpp v124, v124, v124 row_shr:8 row_mask:0xf bank_mask:0xf bound_ctrl:1
v_add_f32_dpp v125, v125, v125 row_shr:8 row_mask:0xf bank_mask:0xf bound_ctrl:1
v_add_f32_dpp v126, v126, v126 row_shr:8 row_mask:0xf bank_mask:0xf bound_ctrl:1
v_add_f32_dpp v127, v127, v127 row_shr:8 row_mask:0xf bank_mask:0xf bound_ctrl:1
v_add_f32_dpp v128, v128, v128 row_shr:8 row_mask:0xf bank_mask:0xf bound_ctrl:1
v_add_f32_dpp v129, v129, v129 row_shr:8 row_mask:0xf bank_mask:0xf bound_ctrl:1
v_add_f32_dpp v122, v122, v122 row_bcast:15 row_mask:0xa bank_mask:0xf
v_add_f32_dpp v123, v123, v123 row_bcast:15 row_mask:0xa bank_mask:0xf
v_add_f32_dpp v124, v124, v124 row_bcast:15 row_mask:0xa bank_mask:0xf
v_add_f32_dpp v125, v125, v125 row_bcast:15 row_mask:0xa bank_mask:0xf
v_add_f32_dpp v126, v126, v126 row_bcast:15 row_mask:0xa bank_mask:0xf
v_add_f32_dpp v127, v127, v127 row_bcast:15 row_mask:0xa bank_mask:0xf
v_add_f32_dpp v128, v128, v128 row_bcast:15 row_mask:0xa bank_mask:0xf
v_add_f32_dpp v129, v129, v129 row_bcast:15 row_mask:0xa bank_mask:0xf
v_add_f32_dpp v122, v122, v122 row_bcast:31 row_mask:0xc bank_mask:0xf
v_add_f32_dpp v123, v123, v123 row_bcast:31 row_mask:0xc bank_mask:0xf
v_add_f32_dpp v124, v124, v124 row_bcast:31 row_mask:0xc bank_mask:0xf
v_add_f32_dpp v125, v125, v125 row_bcast:31 row_mask:0xc bank_mask:0xf
v_add_f32_dpp v126, v126, v126 row_bcast:31 row_mask:0xc bank_mask:0xf
v_add_f32_dpp v127, v127, v127 row_bcast:31 row_mask:0xc bank_mask:0xf
v_add_f32_dpp v128, v128, v128 row_bcast:31 row_mask:0xc bank_mask:0xf
v_add_f32_dpp v129, v129, v129 row_bcast:31 row_mask:0xc bank_mask:0xf
v_mul_f32 v122, 0xbacccccd, v122
v_mul_f32 v123, 0xbacccccd, v123
v_mul_f32 v124, 0xbacccccd, v124
v_mul_f32 v125, 0xbacccccd, v125
v_mul_f32 v126, 0xbacccccd, v126
v_mul_f32 v127, 0xbacccccd, v127
v_mul_f32 v128, 0xbacccccd, v128
v_mul_f32 v129, 0xbacccccd, v129
v_readlane_b32 s78, v122, 63
v_readlane_b32 s80, v123, 63
v_readlane_b32 s82, v124, 63
v_readlane_b32 s84, v125, 63
v_readlane_b32 s86, v126, 63
v_readlane_b32 s88, v127, 63
v_readlane_b32 s90, v128, 63
v_readlane_b32 s92, v129, 63
v_pk_add_f32 v[42:43], v[42:43], s[78:79] op_sel_hi:[1,0]
v_pk_add_f32 v[44:45], v[44:45], s[78:79] op_sel_hi:[1,0]
v_pk_add_f32 v[46:47], v[46:47], s[78:79] op_sel_hi:[1,0]
v_pk_add_f32 v[48:49], v[48:49], s[78:79] op_sel_hi:[1,0]
v_pk_add_f32 v[50:51], v[50:51], s[78:79] op_sel_hi:[1,0]
v_pk_add_f32 v[52:53], v[52:53], s[80:81] op_sel_hi:[1,0]
v_pk_add_f32 v[54:55], v[54:55], s[80:81] op_sel_hi:[1,0]
v_pk_add_f32 v[56:57], v[56:57], s[80:81] op_sel_hi:[1,0]
v_pk_add_f32 v[58:59], v[58:59], s[80:81] op_sel_hi:[1,0]
v_pk_add_f32 v[60:61], v[60:61], s[80:81] op_sel_hi:[1,0]
v_pk_add_f32 v[62:63], v[62:63], s[82:83] op_sel_hi:[1,0]
v_pk_add_f32 v[64:65], v[64:65], s[82:83] op_sel_hi:[1,0]
v_pk_add_f32 v[66:67], v[66:67], s[82:83] op_sel_hi:[1,0]
v_pk_add_f32 v[68:69], v[68:69], s[82:83] op_sel_hi:[1,0]
v_pk_add_f32 v[70:71], v[70:71], s[82:83] op_sel_hi:[1,0]
v_pk_add_f32 v[72:73], v[72:73], s[84:85] op_sel_hi:[1,0]
v_pk_add_f32 v[74:75], v[74:75], s[84:85] op_sel_hi:[1,0]
v_pk_add_f32 v[76:77], v[76:77], s[84:85] op_sel_hi:[1,0]
v_pk_add_f32 v[78:79], v[78:79], s[84:85] op_sel_hi:[1,0]
v_pk_add_f32 v[80:81], v[80:81], s[84:85] op_sel_hi:[1,0]
v_pk_add_f32 v[82:83], v[82:83], s[86:87] op_sel_hi:[1,0]
v_pk_add_f32 v[84:85], v[84:85], s[86:87] op_sel_hi:[1,0]
v_pk_add_f32 v[86:87], v[86:87], s[86:87] op_sel_hi:[1,0]
v_pk_add_f32 v[88:89], v[88:89], s[86:87] op_sel_hi:[1,0]
v_pk_add_f32 v[90:91], v[90:91], s[86:87] op_sel_hi:[1,0]
v_pk_add_f32 v[92:93], v[92:93], s[88:89] op_sel_hi:[1,0]
v_pk_add_f32 v[94:95], v[94:95], s[88:89] op_sel_hi:[1,0]
v_pk_add_f32 v[96:97], v[96:97], s[88:89] op_sel_hi:[1,0]
v_pk_add_f32 v[98:99], v[98:99], s[88:89] op_sel_hi:[1,0]
v_pk_add_f32 v[100:101], v[100:101], s[88:89] op_sel_hi:[1,0]
v_pk_add_f32 v[102:103], v[102:103], s[90:91] op_sel_hi:[1,0]
v_pk_add_f32 v[104:105], v[104:105], s[90:91] op_sel_hi:[1,0]
v_pk_add_f32 v[106:107], v[106:107], s[90:91] op_sel_hi:[1,0]
v_pk_add_f32 v[108:109], v[108:109], s[90:91] op_sel_hi:[1,0]
v_pk_add_f32 v[110:111], v[110:111], s[90:91] op_sel_hi:[1,0]
v_pk_add_f32 v[112:113], v[112:113], s[92:93] op_sel_hi:[1,0]
v_pk_add_f32 v[114:115], v[114:115], s[92:93] op_sel_hi:[1,0]
v_pk_add_f32 v[116:117], v[116:117], s[92:93] op_sel_hi:[1,0]
v_pk_add_f32 v[118:119], v[118:119], s[92:93] op_sel_hi:[1,0]
v_pk_add_f32 v[120:121], v[120:121], s[92:93] op_sel_hi:[1,0]
v_pk_mul_f32 v[130:131], v[42:43], v[42:43]
v_pk_mul_f32 v[132:133], v[52:53], v[52:53]
v_pk_mul_f32 v[134:135], v[62:63], v[62:63]
v_pk_mul_f32 v[136:137], v[72:73], v[72:73]
v_pk_mul_f32 v[138:139], v[82:83], v[82:83]
v_pk_mul_f32 v[140:141], v[92:93], v[92:93]
v_pk_mul_f32 v[142:143], v[102:103], v[102:103]
v_pk_mul_f32 v[144:145], v[112:113], v[112:113]
v_pk_fma_f32 v[130:131], v[44:45], v[44:45], v[130:131]
v_pk_fma_f32 v[132:133], v[54:55], v[54:55], v[132:133]
v_pk_fma_f32 v[134:135], v[64:65], v[64:65], v[134:135]
v_pk_fma_f32 v[136:137], v[74:75], v[74:75], v[136:137]
v_pk_fma_f32 v[138:139], v[84:85], v[84:85], v[138:139]
v_pk_fma_f32 v[140:141], v[94:95], v[94:95], v[140:141]
v_pk_fma_f32 v[142:143], v[104:105], v[104:105], v[142:143]
v_pk_fma_f32 v[144:145], v[114:115], v[114:115], v[144:145]
v_pk_fma_f32 v[130:131], v[46:47], v[46:47], v[130:131]
v_pk_fma_f32 v[132:133], v[56:57], v[56:57], v[132:133]
v_pk_fma_f32 v[134:135], v[66:67], v[66:67], v[134:135]
v_pk_fma_f32 v[136:137], v[76:77], v[76:77], v[136:137]
v_pk_fma_f32 v[138:139], v[86:87], v[86:87], v[138:139]
v_pk_fma_f32 v[140:141], v[96:97], v[96:97], v[140:141]
v_pk_fma_f32 v[142:143], v[106:107], v[106:107], v[142:143]
v_pk_fma_f32 v[144:145], v[116:117], v[116:117], v[144:145]
v_pk_fma_f32 v[130:131], v[48:49], v[48:49], v[130:131]
v_pk_fma_f32 v[132:133], v[58:59], v[58:59], v[132:133]
v_pk_fma_f32 v[134:135], v[68:69], v[68:69], v[134:135]
v_pk_fma_f32 v[136:137], v[78:79], v[78:79], v[136:137]
v_pk_fma_f32 v[138:139], v[88:89], v[88:89], v[138:139]
v_pk_fma_f32 v[140:141], v[98:99], v[98:99], v[140:141]
v_pk_fma_f32 v[142:143], v[108:109], v[108:109], v[142:143]
v_pk_fma_f32 v[144:145], v[118:119], v[118:119], v[144:145]
v_pk_fma_f32 v[130:131], v[50:51], v[50:51], v[130:131]
v_pk_fma_f32 v[132:133], v[60:61], v[60:61], v[132:133]
v_pk_fma_f32 v[134:135], v[70:71], v[70:71], v[134:135]
v_pk_fma_f32 v[136:137], v[80:81], v[80:81], v[136:137]
v_pk_fma_f32 v[138:139], v[90:91], v[90:91], v[138:139]
v_pk_fma_f32 v[140:141], v[100:101], v[100:101], v[140:141]
v_pk_fma_f32 v[142:143], v[110:111], v[110:111], v[142:143]
v_pk_fma_f32 v[144:145], v[120:121], v[120:121], v[144:145]
v_add_f32 v122, v130, v131
v_add_f32 v123, v132, v133
v_add_f32 v124, v134, v135
v_add_f32 v125, v136, v137
v_add_f32 v126, v138, v139
v_add_f32 v127, v140, v141
v_add_f32 v128, v142, v143
v_add_f32 v129, v144, v145
v_add_f32_dpp v122, v122, v122 row_shr:1 row_mask:0xf bank_mask:0xf bound_ctrl:1
v_add_f32_dpp v123, v123, v123 row_shr:1 row_mask:0xf bank_mask:0xf bound_ctrl:1
v_add_f32_dpp v124, v124, v124 row_shr:1 row_mask:0xf bank_mask:0xf bound_ctrl:1
v_add_f32_dpp v125, v125, v125 row_shr:1 row_mask:0xf bank_mask:0xf bound_ctrl:1
v_add_f32_dpp v126, v126, v126 row_shr:1 row_mask:0xf bank_mask:0xf bound_ctrl:1
v_add_f32_dpp v127, v127, v127 row_shr:1 row_mask:0xf bank_mask:0xf bound_ctrl:1
v_add_f32_dpp v128, v128, v128 row_shr:1 row_mask:0xf bank_mask:0xf bound_ctrl:1
v_add_f32_dpp v129, v129, v129 row_shr:1 row_mask:0xf bank_mask:0xf bound_ctrl:1
v_add_f32_dpp v122, v122, v122 row_shr:2 row_mask:0xf bank_mask:0xf bound_ctrl:1
v_add_f32_dpp v123, v123, v123 row_shr:2 row_mask:0xf bank_mask:0xf bound_ctrl:1
v_add_f32_dpp v124, v124, v124 row_shr:2 row_mask:0xf bank_mask:0xf bound_ctrl:1
v_add_f32_dpp v125, v125, v125 row_shr:2 row_mask:0xf bank_mask:0xf bound_ctrl:1
v_add_f32_dpp v126, v126, v126 row_shr:2 row_mask:0xf bank_mask:0xf bound_ctrl:1
v_add_f32_dpp v127, v127, v127 row_shr:2 row_mask:0xf bank_mask:0xf bound_ctrl:1
v_add_f32_dpp v128, v128, v128 row_shr:2 row_mask:0xf bank_mask:0xf bound_ctrl:1
v_add_f32_dpp v129, v129, v129 row_shr:2 row_mask:0xf bank_mask:0xf bound_ctrl:1
v_add_f32_dpp v122, v122, v122 row_shr:4 row_mask:0xf bank_mask:0xf bound_ctrl:1
v_add_f32_dpp v123, v123, v123 row_shr:4 row_mask:0xf bank_mask:0xf bound_ctrl:1
v_add_f32_dpp v124, v124, v124 row_shr:4 row_mask:0xf bank_mask:0xf bound_ctrl:1
v_add_f32_dpp v125, v125, v125 row_shr:4 row_mask:0xf bank_mask:0xf bound_ctrl:1
v_add_f32_dpp v126, v126, v126 row_shr:4 row_mask:0xf bank_mask:0xf bound_ctrl:1
v_add_f32_dpp v127, v127, v127 row_shr:4 row_mask:0xf bank_mask:0xf bound_ctrl:1
v_add_f32_dpp v128, v128, v128 row_shr:4 row_mask:0xf bank_mask:0xf bound_ctrl:1
v_add_f32_dpp v129, v129, v129 row_shr:4 row_mask:0xf bank_mask:0xf bound_ctrl:1
v_add_f32_dpp v122, v122, v122 row_shr:8 row_mask:0xf bank_mask:0xf bound_ctrl:1
v_add_f32_dpp v123, v123, v123 row_shr:8 row_mask:0xf bank_mask:0xf bound_ctrl:1
v_add_f32_dpp v124, v124, v124 row_shr:8 row_mask:0xf bank_mask:0xf bound_ctrl:1
v_add_f32_dpp v125, v125, v125 row_shr:8 row_mask:0xf bank_mask:0xf bound_ctrl:1
v_add_f32_dpp v126, v126, v126 row_shr:8 row_mask:0xf bank_mask:0xf bound_ctrl:1
v_add_f32_dpp v127, v127, v127 row_shr:8 row_mask:0xf bank_mask:0xf bound_ctrl:1
v_add_f32_dpp v128, v128, v128 row_shr:8 row_mask:0xf bank_mask:0xf bound_ctrl:1
v_add_f32_dpp v129, v129, v129 row_shr:8 row_mask:0xf bank_mask:0xf bound_ctrl:1
v_add_f32_dpp v122, v122, v122 row_bcast:15 row_mask:0xa bank_mask:0xf
v_add_f32_dpp v123, v123, v123 row_bcast:15 row_mask:0xa bank_mask:0xf
v_add_f32_dpp v124, v124, v124 row_bcast:15 row_mask:0xa bank_mask:0xf
v_add_f32_dpp v125, v125, v125 row_bcast:15 row_mask:0xa bank_mask:0xf
v_add_f32_dpp v126, v126, v126 row_bcast:15 row_mask:0xa bank_mask:0xf
v_add_f32_dpp v127, v127, v127 row_bcast:15 row_mask:0xa bank_mask:0xf
v_add_f32_dpp v128, v128, v128 row_bcast:15 row_mask:0xa bank_mask:0xf
v_add_f32_dpp v129, v129, v129 row_bcast:15 row_mask:0xa bank_mask:0xf
v_add_f32_dpp v122, v122, v122 row_bcast:31 row_mask:0xc bank_mask:0xf
v_add_f32_dpp v123, v123, v123 row_bcast:31 row_mask:0xc bank_mask:0xf
v_add_f32_dpp v124, v124, v124 row_bcast:31 row_mask:0xc bank_mask:0xf
v_add_f32_dpp v125, v125, v125 row_bcast:31 row_mask:0xc bank_mask:0xf
v_add_f32_dpp v126, v126, v126 row_bcast:31 row_mask:0xc bank_mask:0xf
v_add_f32_dpp v127, v127, v127 row_bcast:31 row_mask:0xc bank_mask:0xf
v_add_f32_dpp v128, v128, v128 row_bcast:31 row_mask:0xc bank_mask:0xf
v_add_f32_dpp v129, v129, v129 row_bcast:31 row_mask:0xc bank_mask:0xf
v_readlane_b32 s79, v122, 63
v_readlane_b32 s81, v123, 63
v_readlane_b32 s83, v124, 63
v_readlane_b32 s85, v125, 63
v_readlane_b32 s87, v126, 63
v_readlane_b32 s89, v127, 63
v_readlane_b32 s91, v128, 63
v_readlane_b32 s93, v129, 63
v_readfirstlane_b32 s67, v203
s_cmp_lg_u32 s67, 0
s_cbranch_scc1 L_epk_3
s_mov_b32 s98, 200000
L_ep_4:
buffer_load_dword v203, v204, s[48:51], 0 offen sc0 sc1
s_waitcnt vmcnt(0)
v_readfirstlane_b32 s67, v203
s_cmp_lg_u32 s67, 0
s_cbranch_scc1 L_epd_5
s_sleep 2
s_sub_u32 s98, s98, 1
s_cmp_lg_u32 s98, 0
s_cbranch_scc1 L_ep_4
L_epd_5:
L_epk_3:
v_mov_b32 v3, s67
v_mov_b32 v5, s67
s_lshl_b32 s56, s73, 4
s_add_u32 s56, s56, s72
s_lshl_b32 s56, s56, 7
s_add_u32 s56, s56, 2686976
s_waitcnt vmcnt(0)
s_mov_b64 exec, 1
buffer_store_dword v3, v204, s[36:39], s56 offen sc0 sc1
s_mov_b64 exec, -1
v_writelane_b32 v2, s79, 0
v_writelane_b32 v4, s78, 0
v_writelane_b32 v2, s81, 1
v_writelane_b32 v4, s80, 1
v_writelane_b32 v2, s83, 2
v_writelane_b32 v4, s82, 2
v_writelane_b32 v2, s85, 3
v_writelane_b32 v4, s84, 3
v_writelane_b32 v2, s87, 4
v_writelane_b32 v4, s86, 4
v_writelane_b32 v2, s89, 5
v_writelane_b32 v4, s88, 5
v_writelane_b32 v2, s91, 6
v_writelane_b32 v4, s90, 6
v_writelane_b32 v2, s93, 7
v_writelane_b32 v4, s92, 7
s_mov_b32 s56, 0x3acccccd
v_mov_b32 v201, 0x3727c5ac
v_fma_f32 v2, v2, s56, v201
v_rsq_f32 v2, v2
v_lshlrev_b32 v201, 4, v1
s_lshl_b32 s56, s77, 7
s_add_u32 s56, s56, 2621440
v_mul_f32 v4, v4, v2
s_mov_b64 exec, 0xff
buffer_store_dwordx4 v[2:5], v201, s[36:39], s56 offen sc0 sc1
s_mov_b64 exec, -1
v_lshrrev_b32 v200, 5, v1
v_lshlrev_b32 v200, 4, v200
v_bfe_u32 v201, v1, 2, 3
v_add_u32 v200, v200, v201
v_mul_u32_u24 v200, 160, v200
v_and_b32 v201, 3, v1
v_mul_u32_u24 v201, 40, v201
v_add_u32 v200, v200, v201
v_add_u32 v200, 64512, v200
v_lshlrev_b32 v201, 4, v1
v_add_u32 v202, 4096, v201
s_waitcnt vmcnt(0)
s_mul_i32 s61, s68, 5120
s_add_u32 s61, s61, 5505024
ds_read_b64_tr_b16 v[42:43], v200 offset:0
ds_read_b64_tr_b16 v[44:45], v200 offset:1280
ds_read_b64_tr_b16 v[46:47], v200 offset:8
ds_read_b64_tr_b16 v[48:49], v200 offset:1288
ds_read_b64_tr_b16 v[50:51], v200 offset:16
ds_read_b64_tr_b16 v[52:53], v200 offset:1296
ds_read_b64_tr_b16 v[54:55], v200 offset:24
ds_read_b64_tr_b16 v[56:57], v200 offset:1304
ds_read_b64_tr_b16 v[58:59], v200 offset:32
ds_read_b64_tr_b16 v[60:61], v200 offset:1312
s_waitcnt lgkmcnt(8)
buffer_store_dwordx4 v[42:45], v201, s[36:39], s61 offen offset:0 sc0 sc1
s_waitcnt lgkmcnt(6)
buffer_store_dwordx4 v[46:49], v201, s[36:39], s61 offen offset:1024 sc0 sc1
s_waitcnt lgkmcnt(4)
buffer_store_dwordx4 v[50:53], v201, s[36:39], s61 offen offset:2048 sc0 sc1
s_waitcnt lgkmcnt(2)
buffer_store_dwordx4 v[54:57], v201, s[36:39], s61 offen offset:3072 sc0 sc1
s_waitcnt lgkmcnt(0)
buffer_store_dwordx4 v[58:61], v202, s[36:39], s61 offen sc0 sc1
s_cmp_lt_u32 s53, 128
s_cbranch_scc1 L_w2u_6
s_mul_i32 s61, s69, 5120
s_add_u32 s61, s61, 5505024
ds_read_b64_tr_b16 v[62:63], v200 offset:5120
ds_read_b64_tr_b16 v[64:65], v200 offset:6400
ds_read_b64_tr_b16 v[66:67], v200 offset:5128
ds_read_b64_tr_b16 v[68:69], v200 offset:6408
ds_read_b64_tr_b16 v[70:71], v200 offset:5136
ds_read_b64_tr_b16 v[72:73], v200 offset:6416
ds_read_b64_tr_b16 v[74:75], v200 offset:5144
ds_read_b64_tr_b16 v[76:77], v200 offset:6424
ds_read_b64_tr_b16 v[78:79], v200 offset:5152
ds_read_b64_tr_b16 v[80:81], v200 offset:6432
s_waitcnt lgkmcnt(8)
buffer_store_dwordx4 v[62:65], v201, s[36:39], s61 offen offset:0 sc0 sc1
s_waitcnt lgkmcnt(6)
buffer_store_dwordx4 v[66:69], v201, s[36:39], s61 offen offset:1024 sc0 sc1
s_waitcnt lgkmcnt(4)
buffer_store_dwordx4 v[70:73], v201, s[36:39], s61 offen offset:2048 sc0 sc1
s_waitcnt lgkmcnt(2)
buffer_store_dwordx4 v[74:77], v201, s[36:39], s61 offen offset:3072 sc0 sc1
s_waitcnt lgkmcnt(0)
buffer_store_dwordx4 v[78:81], v202, s[36:39], s61 offen sc0 sc1
L_w2u_6:
s_mul_i32 s56, s64, 1639
s_lshr_b32 s56, s56, 16
s_add_u32 s57, s64, s63
s_sub_u32 s57, s57, 1
s_mul_i32 s57, s57, 1639
s_lshr_b32 s57, s57, 16
s_lshl_b32 s56, s56, 11
s_lshl_b32 s57, s57, 11
v_mov_b32 v201, s56
v_mov_b32 v202, s57
v_and_b32 v203, 16, v1
v_cmp_eq_u32 vcc, 0, v203
s_nop 1
v_cndmask_b32 v201, v202, v201, vcc
v_and_b32 v203, 15, v1
v_lshlrev_b32 v203, 7, v203
v_add_u32 v201, v201, v203
s_mov_b32 s56, 2686976
s_lshl_b32 s68, s68, 7
s_add_u32 s68, s68, 13893632
s_lshl_b32 s69, s69, 7
s_add_u32 s69, s69, 13893632
s_waitcnt vmcnt(0)
s_mov_b64 exec, 1
buffer_store_dword v3, v204, s[36:39], s68 offen sc0 sc1
s_cmp_lt_u32 s53, 128
s_cbranch_scc1 L_w3u_7
buffer_store_dword v3, v204, s[36:39], s69 offen sc0 sc1
L_w3u_7:
s_mov_b64 exec, -1
s_mov_b32 s98, 200000
L_poll_8:
buffer_load_dword v6, v201, s[36:39], s56 offen sc0 sc1
s_waitcnt vmcnt(0)
v_cmp_ne_u32 vcc, s67, v6
s_nop 1
s_cmp_eq_u64 vcc, 0
s_cbranch_scc1 L_polld_9
s_sleep 4
s_sub_u32 s98, s98, 1
s_cmp_lg_u32 s98, 0
s_cbranch_scc1 L_poll_8
L_polld_9:
L_A_stage:
s_setprio 1
v_mov_b32 v49, 0
v_sub_u32 v46, 63, v1
v_lshlrev_b32 v48, 2, v46
v_lshlrev_b32 v46, 5, v46
s_lshl_b32 s56, s52, 2
s_sub_u32 s56, 12, s56
s_lshl_b32 s57, s56, 11
s_add_u32 s57, s57, 2621440
s_lshl_b32 s58, s56, 8
s_lshl_b32 s59, s64, 12
s_add_u32 s58, s58, s59
s_add_u32 s58, s58, 0
s_add_u32 s59, s58, 4096
s_add_u32 s60, s58, 8192
s_add_u32 s61, s57, 4096
v_lshlrev_b32 v47, 4, v1
v_add_u32 v47, 52224, v47
s_mov_b32 s98, 200000
s_waitcnt lgkmcnt(0)
s_barrier
buffer_load_dword v74, v49, s[48:51], 0 offen sc0 sc1
buffer_load_dword v34, v48, s[36:39], s58 offen offset:768 sc0 sc1
buffer_load_dword v38, v48, s[36:39], s59 offen offset:768 sc0 sc1
buffer_load_dword v42, v48, s[36:39], s60 offen offset:768 sc0 sc1
buffer_load_dword v35, v48, s[36:39], s58 offen offset:512 sc0 sc1
buffer_load_dword v39, v48, s[36:39], s59 offen offset:512 sc0 sc1
buffer_load_dword v43, v48, s[36:39], s60 offen offset:512 sc0 sc1
buffer_load_dword v36, v48, s[36:39], s58 offen offset:256 sc0 sc1
buffer_load_dword v40, v48, s[36:39], s59 offen offset:256 sc0 sc1
buffer_load_dword v44, v48, s[36:39], s60 offen offset:256 sc0 sc1
buffer_load_dword v37, v48, s[36:39], s58 offen offset:0 sc0 sc1
buffer_load_dword v41, v48, s[36:39], s59 offen offset:0 sc0 sc1
buffer_load_dword v45, v48, s[36:39], s60 offen offset:0 sc0 sc1
L_sret_10:
buffer_load_dwordx4 v[2:5], v46, s[36:39], s61 offen offset:2048 sc0 sc1
buffer_load_dwordx4 v[6:9], v46, s[36:39], s61 offen offset:2064 sc0 sc1
buffer_load_dwordx4 v[10:13], v46, s[36:39], s61 offen offset:0 sc0 sc1
buffer_load_dwordx4 v[14:17], v46, s[36:39], s61 offen offset:16 sc0 sc1
buffer_load_dwordx4 v[18:21], v46, s[36:39], s57 offen offset:2048 sc0 sc1
buffer_load_dwordx4 v[22:25], v46, s[36:39], s57 offen offset:2064 sc0 sc1
buffer_load_dwordx4 v[26:29], v46, s[36:39], s57 offen offset:0 sc0 sc1
buffer_load_dwordx4 v[30:33], v46, s[36:39], s57 offen offset:16 sc0 sc1
s_waitcnt vmcnt(0)
v_readfirstlane_b32 s67, v74
v_mov_b32 v50, 0
s_nop 0
v_xor_b32 v51, s67, v3
v_xor_b32 v52, s67, v5
v_or3_b32 v50, v50, v51, v52
v_xor_b32 v51, s67, v7
v_xor_b32 v52, s67, v9
v_or3_b32 v50, v50, v51, v52
v_xor_b32 v51, s67, v11
v_xor_b32 v52, s67, v13
v_or3_b32 v50, v50, v51, v52
v_xor_b32 v51, s67, v15
v_xor_b32 v52, s67, v17
v_or3_b32 v50, v50, v51, v52
v_xor_b32 v51, s67, v19
v_xor_b32 v52, s67, v21
v_or3_b32 v50, v50, v51, v52
v_xor_b32 v51, s67, v23
v_xor_b32 v52, s67, v25
v_or3_b32 v50, v50, v51, v52
v_xor_b32 v51, s67, v27
v_xor_b32 v52, s67, v29
v_or3_b32 v50, v50, v51, v52
v_xor_b32 v51, s67, v31
v_xor_b32 v52, s67, v33
v_or3_b32 v50, v50, v51, v52
v_cmp_ne_u32 vcc, 0, v50
s_nop 1
s_cmp_eq_u64 vcc, 0
s_cbranch_scc1 L_sgo_11
s_sub_u32 s98, s98, 1
s_cmp_eq_u32 s98, 0
s_cbranch_scc1 L_sgo_11
s_sleep 4
s_branch L_sret_10
L_sgo_11:
v_mov_b32 v70, 0
v_mov_b32 v71, 0
v_mov_b32 v72, 0
v_mov_b32 v73, 0
s_cmp_lg_u32 s52, 3
s_cbranch_scc1 L_noz_12
s_mov_b64 exec, 0xf
ds_write_b128 v47, v[70:73] offset:8320
ds_write_b128 v47, v[70:73] offset:4096
ds_write_b128 v47, v[70:73] offset:16768
ds_write_b128 v47, v[70:73] offset:12544
ds_write_b128 v47, v[70:73] offset:25216
ds_write_b128 v47, v[70:73] offset:20992
s_mov_b64 exec, -1
L_noz_12:
s_lshl_b32 s56, s52, 10
s_add_u32 s56, s56, 52224
s_mov_b32 m0, s56
s_waitcnt vmcnt(0)
v_lshlrev_b32 v50, 16, v34
v_and_b32 v51, 0xffff0000, v34
v_lshlrev_b32 v52, 16, v38
v_and_b32 v53, 0xffff0000, v38
v_lshlrev_b32 v54, 16, v42
v_and_b32 v55, 0xffff0000, v42
v_fma_f32 v50, v50, v2, v4
v_fma_f32 v51, v51, v6, v8
v_fma_f32 v52, v52, v2, v4
v_fma_f32 v53, v53, v6, v8
v_fma_f32 v54, v54, v2, v4
v_fma_f32 v55, v55, v6, v8
v_cvt_pk_bf16_f32 v56, v51, v50
v_cvt_pk_bf16_f32 v57, v53, v52
v_cvt_pk_bf16_f32 v58, v55, v54
v_lshlrev_b32 v59, 16, v35
v_and_b32 v60, 0xffff0000, v35
v_lshlrev_b32 v61, 16, v39
v_and_b32 v62, 0xffff0000, v39
v_lshlrev_b32 v63, 16, v43
v_and_b32 v64, 0xffff0000, v43
v_fma_f32 v59, v59, v10, v12
v_fma_f32 v60, v60, v14, v16
v_fma_f32 v61, v61, v10, v12
v_fma_f32 v62, v62, v14, v16
v_fma_f32 v63, v63, v10, v12
v_fma_f32 v64, v64, v14, v16
v_cvt_pk_bf16_f32 v65, v60, v59
v_cvt_pk_bf16_f32 v66, v62, v61
v_cvt_pk_bf16_f32 v67, v64, v63
ds_write_addtid_b32 v56 offset:4224
ds_write_addtid_b32 v56 offset:4
ds_write_addtid_b32 v57 offset:12672
ds_write_addtid_b32 v57 offset:8452
ds_write_addtid_b32 v58 offset:21120
ds_write_addtid_b32 v58 offset:16900
v_lshlrev_b32 v50, 16, v36
v_and_b32 v51, 0xffff0000, v36
v_lshlrev_b32 v52, 16, v40
v_and_b32 v53, 0xffff0000, v40
v_lshlrev_b32 v54, 16, v44
v_and_b32 v55, 0xffff0000, v44
v_fma_f32 v50, v50, v18, v20
v_fma_f32 v51, v51, v22, v24
v_fma_f32 v52, v52, v18, v20
v_fma_f32 v53, v53, v22, v24
v_fma_f32 v54, v54, v18, v20
v_fma_f32 v55, v55, v22, v24
v_cvt_pk_bf16_f32 v56, v51, v50
v_cvt_pk_bf16_f32 v57, v53, v52
v_cvt_pk_bf16_f32 v58, v55, v54
ds_write_addtid_b32 v65 offset:4480
ds_write_addtid_b32 v65 offset:260
ds_write_addtid_b32 v66 offset:12928
ds_write_addtid_b32 v66 offset:8708
ds_write_addtid_b32 v67 offset:21376
ds_write_addtid_b32 v67 offset:17156
v_lshlrev_b32 v59, 16, v37
v_and_b32 v60, 0xffff0000, v37
v_lshlrev_b32 v61, 16, v41
v_and_b32 v62, 0xffff0000, v41
v_lshlrev_b32 v63, 16, v45
v_and_b32 v64, 0xffff0000, v45
v_fma_f32 v59, v59, v26, v28
v_fma_f32 v60, v60, v30, v32
v_fma_f32 v61, v61, v26, v28
v_fma_f32 v62, v62, v30, v32
v_fma_f32 v63, v63, v26, v28
v_fma_f32 v64, v64, v30, v32
v_cvt_pk_bf16_f32 v65, v60, v59
v_cvt_pk_bf16_f32 v66, v62, v61
v_cvt_pk_bf16_f32 v67, v64, v63
ds_write_addtid_b32 v56 offset:4736
ds_write_addtid_b32 v56 offset:516
ds_write_addtid_b32 v57 offset:13184
ds_write_addtid_b32 v57 offset:8964
ds_write_addtid_b32 v58 offset:21632
ds_write_addtid_b32 v58 offset:17412
ds_write_addtid_b32 v65 offset:4992
ds_write_addtid_b32 v65 offset:772
ds_write_addtid_b32 v66 offset:13440
ds_write_addtid_b32 v66 offset:9220
ds_write_addtid_b32 v67 offset:21888
ds_write_addtid_b32 v67 offset:17668
buffer_load_dword v7, v49, s[48:51], 0 offen sc0 sc1
s_setprio 1
v_and_b32 v8, 15, v1
v_lshrrev_b32 v9, 4, v1
v_and_b32 v10, 1, v1
v_mul_u32_u24 v2, 4576, v10
v_lshrrev_b32 v11, 1, v8
v_lshlrev_b32 v11, 6, v11
v_add_u32 v2, v2, v11
v_lshlrev_b32 v11, 4, v9
v_add_u32 v2, v2, v11
v_mul_u32_u24 v3, 4224, v10
v_add_u32 v3, v3, v11
v_add_u32 v11, v8, v10
v_lshlrev_b32 v11, 2, v11
v_sub_u32 v3, v3, v11
v_add_u32 v3, 52288, v3
v_lshlrev_b32 v4, 4, v1
v_add_u32 v4, 9120, v4
s_lshl_b32 s54, s63, 1
s_mul_i32 s55, s54, s52
s_add_u32 s56, s55, s54
v_mov_b32 v12, 0
v_mov_b32 v13, 0
v_mov_b32 v14, 0
v_mov_b32 v15, 0
v_mov_b32 v16, 0
v_mov_b32 v17, 0
v_mov_b32 v18, 0
v_mov_b32 v19, 0
v_mov_b32 v20, 0
v_mov_b32 v21, 0
v_mov_b32 v22, 0
v_mov_b32 v23, 0
v_mov_b32 v24, 0
v_mov_b32 v25, 0
v_mov_b32 v26, 0
v_mov_b32 v27, 0
v_mov_b32 v28, 0
v_mov_b32 v29, 0
v_mov_b32 v30, 0
v_mov_b32 v31, 0
v_mov_b32 v32, 0
v_mov_b32 v33, 0
v_mov_b32 v34, 0
v_mov_b32 v35, 0
v_mov_b32 v36, 0
v_mov_b32 v37, 0
v_mov_b32 v38, 0
v_mov_b32 v39, 0
v_mov_b32 v40, 0
v_mov_b32 v41, 0
v_mov_b32 v42, 0
v_mov_b32 v43, 0
s_cmp_lg_u32 s52, 3
s_cbranch_scc1 L_cw_13
s_lshl_b32 s57, s77, 7
s_add_u32 s57, s57, 13959168
v_mov_b32 v8, 64
s_mov_b32 s98, 200000
L_cwp_14:
buffer_load_dword v9, v8, s[36:39], s57 offen sc0 sc1
s_waitcnt vmcnt(0)
v_cmp_ne_u32 vcc, s67, v9
s_nop 1
s_cmp_eq_u64 vcc, 0
s_cbranch_scc1 L_cw_13
s_sub_u32 s98, s98, 1
s_cmp_eq_u32 s98, 0
s_cbranch_scc1 L_cw_13
s_sleep 4
s_branch L_cwp_14
L_cw_13:
s_waitcnt lgkmcnt(0)
s_barrier
s_lshr_b32 s57, s55, 3
s_and_b32 s58, s55, 7
s_lshl_b32 s58, s58, 6
s_mul_i32 s59, s57, 17408
s_mul_i32 s60, s57, 8448
s_add_u32 s59, s59, s58
s_add_u32 s60, s60, s58
v_add_u32 v5, s59, v2
v_add_u32 v6, s60, v3
ds_read_b128 v[44:47], v5 offset:0
ds_read_b64 v[76:77], v6 offset:3584
ds_read_b64 v[78:79], v6 offset:3592
ds_read_b128 v[48:51], v5 offset:512
ds_read_b64 v[80:81], v6 offset:3072
ds_read_b64 v[82:83], v6 offset:3080
ds_read_b128 v[52:55], v5 offset:1024
ds_read_b64 v[84:85], v6 offset:2560
ds_read_b64 v[86:87], v6 offset:2568
ds_read_b128 v[56:59], v5 offset:1536
ds_read_b64 v[88:89], v6 offset:2048
ds_read_b64 v[90:91], v6 offset:2056
ds_read_b128 v[60:63], v5 offset:2048
ds_read_b64 v[92:93], v6 offset:1536
ds_read_b64 v[94:95], v6 offset:1544
ds_read_b128 v[64:67], v5 offset:2560
ds_read_b64 v[96:97], v6 offset:1024
ds_read_b64 v[98:99], v6 offset:1032
ds_read_b128 v[68:71], v5 offset:3072
ds_read_b64 v[100:101], v6 offset:512
ds_read_b64 v[102:103], v6 offset:520
ds_read_b128 v[72:75], v5 offset:3584
ds_read_b64 v[104:105], v6 offset:0
ds_read_b64 v[106:107], v6 offset:8
L_cv_15:
s_add_u32 s55, s55, 1
s_lshr_b32 s57, s55, 3
s_and_b32 s58, s55, 7
s_lshl_b32 s58, s58, 6
s_mul_i32 s59, s57, 17408
s_mul_i32 s60, s57, 8448
s_add_u32 s59, s59, s58
s_add_u32 s60, s60, s58
v_add_u32 v5, s59, v2
v_add_u32 v6, s60, v3
s_waitcnt lgkmcnt(0)
v_mfma_f32_16x16x32_bf16 v[12:15], v[44:47], v[76:79], v[12:15]
ds_read_b128 v[108:111], v5 offset:0
v_mfma_f32_16x16x32_bf16 v[16:19], v[44:47], v[80:83], v[16:19]
ds_read_b64 v[140:141], v6 offset:3584
v_mfma_f32_16x16x32_bf16 v[20:23], v[44:47], v[84:87], v[20:23]
ds_read_b64 v[142:143], v6 offset:3592
v_mfma_f32_16x16x32_bf16 v[24:27], v[44:47], v[88:91], v[24:27]
ds_read_b128 v[112:115], v5 offset:512
v_mfma_f32_16x16x32_bf16 v[28:31], v[44:47], v[92:95], v[28:31]
ds_read_b64 v[144:145], v6 offset:3072
v_mfma_f32_16x16x32_bf16 v[32:35], v[44:47], v[96:99], v[32:35]
ds_read_b64 v[146:147], v6 offset:3080
v_mfma_f32_16x16x32_bf16 v[36:39], v[44:47], v[100:103], v[36:39]
ds_read_b128 v[116:119], v5 offset:1024
v_mfma_f32_16x16x32_bf16 v[40:43], v[44:47], v[104:107], v[40:43]
ds_read_b64 v[148:149], v6 offset:2560
v_mfma_f32_16x16x32_bf16 v[16:19], v[48:51], v[76:79], v[16:19]
ds_read_b64 v[150:151], v6 offset:2568
v_mfma_f32_16x16x32_bf16 v[20:23], v[48:51], v[80:83], v[20:23]
ds_read_b128 v[120:123], v5 offset:1536
v_mfma_f32_16x16x32_bf16 v[24:27], v[48:51], v[84:87], v[24:27]
ds_read_b64 v[152:153], v6 offset:2048
v_mfma_f32_16x16x32_bf16 v[28:31], v[48:51], v[88:91], v[28:31]
ds_read_b64 v[154:155], v6 offset:2056
v_mfma_f32_16x16x32_bf16 v[32:35], v[48:51], v[92:95], v[32:35]
v_mfma_f32_16x16x32_bf16 v[36:39], v[48:51], v[96:99], v[36:39]
ds_read_b128 v[124:127], v5 offset:2048
v_mfma_f32_16x16x32_bf16 v[40:43], v[48:51], v[100:103], v[40:43]
v_mfma_f32_16x16x32_bf16 v[20:23], v[52:55], v[76:79], v[20:23]
ds_read_b64 v[156:157], v6 offset:1536
v_mfma_f32_16x16x32_bf16 v[24:27], v[52:55], v[80:83], v[24:27]
v_mfma_f32_16x16x32_bf16 v[28:31], v[52:55], v[84:87], v[28:31]
ds_read_b64 v[158:159], v6 offset:1544
v_mfma_f32_16x16x32_bf16 v[32:35], v[52:55], v[88:91], v[32:35]
v_mfma_f32_16x16x32_bf16 v[36:39], v[52:55], v[92:95], v[36:39]
ds_read_b128 v[128:131], v5 offset:2560
v_mfma_f32_16x16x32_bf16 v[40:43], v[52:55], v[96:99], v[40:43]
v_mfma_f32_16x16x32_bf16 v[24:27], v[56:59], v[76:79], v[24:27]
ds_read_b64 v[160:161], v6 offset:1024
v_mfma_f32_16x16x32_bf16 v[28:31], v[56:59], v[80:83], v[28:31]
v_mfma_f32_16x16x32_bf16 v[32:35], v[56:59], v[84:87], v[32:35]
ds_read_b64 v[162:163], v6 offset:1032
v_mfma_f32_16x16x32_bf16 v[36:39], v[56:59], v[88:91], v[36:39]
v_mfma_f32_16x16x32_bf16 v[40:43], v[56:59], v[92:95], v[40:43]
ds_read_b128 v[132:135], v5 offset:3072
v_mfma_f32_16x16x32_bf16 v[28:31], v[60:63], v[76:79], v[28:31]
v_mfma_f32_16x16x32_bf16 v[32:35], v[60:63], v[80:83], v[32:35]
ds_read_b64 v[164:165], v6 offset:512
v_mfma_f32_16x16x32_bf16 v[36:39], v[60:63], v[84:87], v[36:39]
v_mfma_f32_16x16x32_bf16 v[40:43], v[60:63], v[88:91], v[40:43]
ds_read_b64 v[166:167], v6 offset:520
v_mfma_f32_16x16x32_bf16 v[32:35], v[64:67], v[76:79], v[32:35]
v_mfma_f32_16x16x32_bf16 v[36:39], v[64:67], v[80:83], v[36:39]
ds_read_b128 v[136:139], v5 offset:3584
v_mfma_f32_16x16x32_bf16 v[40:43], v[64:67], v[84:87], v[40:43]
v_mfma_f32_16x16x32_bf16 v[36:39], v[68:71], v[76:79], v[36:39]
ds_read_b64 v[168:169], v6 offset:0
v_mfma_f32_16x16x32_bf16 v[40:43], v[68:71], v[80:83], v[40:43]
v_mfma_f32_16x16x32_bf16 v[40:43], v[72:75], v[76:79], v[40:43]
ds_read_b64 v[170:171], v6 offset:8
s_add_u32 s55, s55, 1
s_lshr_b32 s57, s55, 3
s_and_b32 s58, s55, 7
s_lshl_b32 s58, s58, 6
s_mul_i32 s59, s57, 17408
s_mul_i32 s60, s57, 8448
s_add_u32 s59, s59, s58
s_add_u32 s60, s60, s58
v_add_u32 v5, s59, v2
v_add_u32 v6, s60, v3
s_waitcnt lgkmcnt(0)
v_mfma_f32_16x16x32_bf16 v[12:15], v[108:111], v[140:143], v[12:15]
ds_read_b128 v[44:47], v5 offset:0
v_mfma_f32_16x16x32_bf16 v[16:19], v[108:111], v[144:147], v[16:19]
ds_read_b64 v[76:77], v6 offset:3584
v_mfma_f32_16x16x32_bf16 v[20:23], v[108:111], v[148:151], v[20:23]
ds_read_b64 v[78:79], v6 offset:3592
v_mfma_f32_16x16x32_bf16 v[24:27], v[108:111], v[152:155], v[24:27]
ds_read_b128 v[48:51], v5 offset:512
v_mfma_f32_16x16x32_bf16 v[28:31], v[108:111], v[156:159], v[28:31]
ds_read_b64 v[80:81], v6 offset:3072
v_mfma_f32_16x16x32_bf16 v[32:35], v[108:111], v[160:163], v[32:35]
ds_read_b64 v[82:83], v6 offset:3080
v_mfma_f32_16x16x32_bf16 v[36:39], v[108:111], v[164:167], v[36:39]
ds_read_b128 v[52:55], v5 offset:1024
v_mfma_f32_16x16x32_bf16 v[40:43], v[108:111], v[168:171], v[40:43]
ds_read_b64 v[84:85], v6 offset:2560
v_mfma_f32_16x16x32_bf16 v[16:19], v[112:115], v[140:143], v[16:19]
ds_read_b64 v[86:87], v6 offset:2568
v_mfma_f32_16x16x32_bf16 v[20:23], v[112:115], v[144:147], v[20:23]
ds_read_b128 v[56:59], v5 offset:1536
v_mfma_f32_16x16x32_bf16 v[24:27], v[112:115], v[148:151], v[24:27]
ds_read_b64 v[88:89], v6 offset:2048
v_mfma_f32_16x16x32_bf16 v[28:31], v[112:115], v[152:155], v[28:31]
ds_read_b64 v[90:91], v6 offset:2056
v_mfma_f32_16x16x32_bf16 v[32:35], v[112:115], v[156:159], v[32:35]
v_mfma_f32_16x16x32_bf16 v[36:39], v[112:115], v[160:163], v[36:39]
ds_read_b128 v[60:63], v5 offset:2048
v_mfma_f32_16x16x32_bf16 v[40:43], v[112:115], v[164:167], v[40:43]
v_mfma_f32_16x16x32_bf16 v[20:23], v[116:119], v[140:143], v[20:23]
ds_read_b64 v[92:93], v6 offset:1536
v_mfma_f32_16x16x32_bf16 v[24:27], v[116:119], v[144:147], v[24:27]
v_mfma_f32_16x16x32_bf16 v[28:31], v[116:119], v[148:151], v[28:31]
ds_read_b64 v[94:95], v6 offset:1544
v_mfma_f32_16x16x32_bf16 v[32:35], v[116:119], v[152:155], v[32:35]
v_mfma_f32_16x16x32_bf16 v[36:39], v[116:119], v[156:159], v[36:39]
ds_read_b128 v[64:67], v5 offset:2560
v_mfma_f32_16x16x32_bf16 v[40:43], v[116:119], v[160:163], v[40:43]
v_mfma_f32_16x16x32_bf16 v[24:27], v[120:123], v[140:143], v[24:27]
ds_read_b64 v[96:97], v6 offset:1024
v_mfma_f32_16x16x32_bf16 v[28:31], v[120:123], v[144:147], v[28:31]
v_mfma_f32_16x16x32_bf16 v[32:35], v[120:123], v[148:151], v[32:35]
ds_read_b64 v[98:99], v6 offset:1032
v_mfma_f32_16x16x32_bf16 v[36:39], v[120:123], v[152:155], v[36:39]
v_mfma_f32_16x16x32_bf16 v[40:43], v[120:123], v[156:159], v[40:43]
ds_read_b128 v[68:71], v5 offset:3072
v_mfma_f32_16x16x32_bf16 v[28:31], v[124:127], v[140:143], v[28:31]
v_mfma_f32_16x16x32_bf16 v[32:35], v[124:127], v[144:147], v[32:35]
ds_read_b64 v[100:101], v6 offset:512
v_mfma_f32_16x16x32_bf16 v[36:39], v[124:127], v[148:151], v[36:39]
v_mfma_f32_16x16x32_bf16 v[40:43], v[124:127], v[152:155], v[40:43]
ds_read_b64 v[102:103], v6 offset:520
v_mfma_f32_16x16x32_bf16 v[32:35], v[128:131], v[140:143], v[32:35]
v_mfma_f32_16x16x32_bf16 v[36:39], v[128:131], v[144:147], v[36:39]
ds_read_b128 v[72:75], v5 offset:3584
v_mfma_f32_16x16x32_bf16 v[40:43], v[128:131], v[148:151], v[40:43]
v_mfma_f32_16x16x32_bf16 v[36:39], v[132:135], v[140:143], v[36:39]
ds_read_b64 v[104:105], v6 offset:0
v_mfma_f32_16x16x32_bf16 v[40:43], v[132:135], v[144:147], v[40:43]
v_mfma_f32_16x16x32_bf16 v[40:43], v[136:139], v[140:143], v[40:43]
ds_read_b64 v[106:107], v6 offset:8
s_cmp_eq_u32 s55, s56
s_cbranch_scc1 L_cve_17
s_and_b32 s58, s55, 7
s_cmp_lg_u32 s58, 0
s_cbranch_scc1 L_cv_15
s_lshr_b32 s57, s55, 3
s_sub_u32 s57, s57, 1
s_mul_i32 s57, s57, 17408
v_add_u32 v8, s57, v4
s_nop 5
ds_write_b128 v8, v[12:15] offset:0
ds_write_b128 v8, v[16:19] offset:1024
ds_write_b128 v8, v[20:23] offset:2048
ds_write_b128 v8, v[24:27] offset:3072
ds_write_b128 v8, v[28:31] offset:4096
ds_write_b128 v8, v[32:35] offset:5120
ds_write_b128 v8, v[36:39] offset:6144
ds_write_b128 v8, v[40:43] offset:7168
v_mov_b32 v12, 0
v_mov_b32 v13, 0
v_mov_b32 v14, 0
v_mov_b32 v15, 0
v_mov_b32 v16, 0
v_mov_b32 v17, 0
v_mov_b32 v18, 0
v_mov_b32 v19, 0
v_mov_b32 v20, 0
v_mov_b32 v21, 0
v_mov_b32 v22, 0
v_mov_b32 v23, 0
v_mov_b32 v24, 0
v_mov_b32 v25, 0
v_mov_b32 v26, 0
v_mov_b32 v27, 0
v_mov_b32 v28, 0
v_mov_b32 v29, 0
v_mov_b32 v30, 0
v_mov_b32 v31, 0
v_mov_b32 v32, 0
v_mov_b32 v33, 0
v_mov_b32 v34, 0
v_mov_b32 v35, 0
v_mov_b32 v36, 0
v_mov_b32 v37, 0
v_mov_b32 v38, 0
v_mov_b32 v39, 0
v_mov_b32 v40, 0
v_mov_b32 v41, 0
v_mov_b32 v42, 0
v_mov_b32 v43, 0
s_branch L_cv_15
L_cve_17:
s_setprio 3
s_sub_u32 s57, s56, 1
s_lshr_b32 s57, s57, 3
s_mul_i32 s58, s57, 17408
v_add_u32 v8, s58, v4
s_and_b32 s59, s52, 1
s_cmp_eq_u32 s52, 2
s_cselect_b32 s60, 1, 0
s_cmp_eq_u32 s63, 3
s_cselect_b32 s59, s60, s59
s_cmp_eq_u32 s59, 0
s_cbranch_scc1 L_nofl_18
s_nop 8
ds_write_b128 v8, v[12:15] offset:0
ds_write_b128 v8, v[16:19] offset:1024
ds_write_b128 v8, v[20:23] offset:2048
ds_write_b128 v8, v[24:27] offset:3072
ds_write_b128 v8, v[28:31] offset:4096
ds_write_b128 v8, v[32:35] offset:5120
ds_write_b128 v8, v[36:39] offset:6144
ds_write_b128 v8, v[40:43] offset:7168
L_nofl_18:
s_waitcnt lgkmcnt(0)
s_barrier
s_cmp_lg_u32 s59, 0
s_cbranch_scc1 L_cvx_19
ds_read_b128 v[44:47], v8 offset:0
ds_read_b128 v[48:51], v8 offset:1024
ds_read_b128 v[52:55], v8 offset:2048
ds_read_b128 v[56:59], v8 offset:3072
ds_read_b128 v[60:63], v8 offset:4096
ds_read_b128 v[64:67], v8 offset:5120
ds_read_b128 v[68:71], v8 offset:6144
ds_read_b128 v[72:75], v8 offset:7168
v_lshrrev_b32 v9, 4, v1
v_lshlrev_b32 v9, 7, v9
v_and_b32 v10, 15, v1
v_lshlrev_b32 v10, 2, v10
v_add_u32 v9, v10, v9
s_add_u32 s61, s57, s64
s_mul_i32 s57, s61, 4160
s_add_u32 s57, s57, 2818048
s_waitcnt lgkmcnt(7)
v_pk_add_f32 v[44:45], v[44:45], v[12:13]
v_pk_add_f32 v[46:47], v[46:47], v[14:15]
v_cvt_pk_bf16_f32 v12, v44, v45
v_cvt_pk_bf16_f32 v13, v46, v47
s_waitcnt lgkmcnt(6)
v_pk_add_f32 v[48:49], v[48:49], v[16:17]
v_pk_add_f32 v[50:51], v[50:51], v[18:19]
v_cvt_pk_bf16_f32 v16, v48, v49
v_cvt_pk_bf16_f32 v17, v50, v51
buffer_store_dword v12, v9, s[36:39], s57 offen offset:0 sc0 sc1
buffer_store_dword v13, v9, s[36:39], s57 offen offset:64 sc0 sc1
s_waitcnt lgkmcnt(5)
v_pk_add_f32 v[52:53], v[52:53], v[20:21]
v_pk_add_f32 v[54:55], v[54:55], v[22:23]
v_cvt_pk_bf16_f32 v20, v52, v53
v_cvt_pk_bf16_f32 v21, v54, v55
buffer_store_dword v16, v9, s[36:39], s57 offen offset:512 sc0 sc1
buffer_store_dword v17, v9, s[36:39], s57 offen offset:576 sc0 sc1
s_waitcnt lgkmcnt(4)
v_pk_add_f32 v[56:57], v[56:57], v[24:25]
v_pk_add_f32 v[58:59], v[58:59], v[26:27]
v_cvt_pk_bf16_f32 v24, v56, v57
v_cvt_pk_bf16_f32 v25, v58, v59
buffer_store_dword v20, v9, s[36:39], s57 offen offset:1024 sc0 sc1
buffer_store_dword v21, v9, s[36:39], s57 offen offset:1088 sc0 sc1
s_waitcnt lgkmcnt(3)
v_pk_add_f32 v[60:61], v[60:61], v[28:29]
v_pk_add_f32 v[62:63], v[62:63], v[30:31]
v_cvt_pk_bf16_f32 v28, v60, v61
v_cvt_pk_bf16_f32 v29, v62, v63
buffer_store_dword v24, v9, s[36:39], s57 offen offset:1536 sc0 sc1
buffer_store_dword v25, v9, s[36:39], s57 offen offset:1600 sc0 sc1
s_waitcnt lgkmcnt(2)
v_pk_add_f32 v[64:65], v[64:65], v[32:33]
v_pk_add_f32 v[66:67], v[66:67], v[34:35]
v_cvt_pk_bf16_f32 v32, v64, v65
v_cvt_pk_bf16_f32 v33, v66, v67
buffer_store_dword v28, v9, s[36:39], s57 offen offset:2048 sc0 sc1
buffer_store_dword v29, v9, s[36:39], s57 offen offset:2112 sc0 sc1
s_waitcnt lgkmcnt(1)
v_pk_add_f32 v[68:69], v[68:69], v[36:37]
v_pk_add_f32 v[70:71], v[70:71], v[38:39]
v_cvt_pk_bf16_f32 v36, v68, v69
v_cvt_pk_bf16_f32 v37, v70, v71
buffer_store_dword v32, v9, s[36:39], s57 offen offset:2560 sc0 sc1
buffer_store_dword v33, v9, s[36:39], s57 offen offset:2624 sc0 sc1
s_waitcnt lgkmcnt(0)
v_pk_add_f32 v[72:73], v[72:73], v[40:41]
v_pk_add_f32 v[74:75], v[74:75], v[42:43]
v_cvt_pk_bf16_f32 v40, v72, v73
v_cvt_pk_bf16_f32 v41, v74, v75
buffer_store_dword v36, v9, s[36:39], s57 offen offset:3072 sc0 sc1
buffer_store_dword v37, v9, s[36:39], s57 offen offset:3136 sc0 sc1
buffer_store_dword v40, v9, s[36:39], s57 offen offset:3584 sc0 sc1
buffer_store_dword v41, v9, s[36:39], s57 offen offset:3648 sc0 sc1
v_mov_b32 v8, 0
s_waitcnt vmcnt(0)
v_readfirstlane_b32 s67, v7
s_cmp_lg_u32 s67, 0
s_cbranch_scc1 L_cepk_20
s_mov_b32 s98, 200000
L_ep_21:
buffer_load_dword v7, v8, s[48:51], 0 offen sc0 sc1
s_waitcnt vmcnt(0)
v_readfirstlane_b32 s67, v7
s_cmp_lg_u32 s67, 0
s_cbranch_scc1 L_epd_22
s_sleep 2
s_sub_u32 s98, s98, 1
s_cmp_lg_u32 s98, 0
s_cbranch_scc1 L_ep_21
L_epd_22:
L_cepk_20:
s_lshl_b32 s61, s61, 7
s_add_u32 s61, s61, 13762560
v_mov_b32 v7, s67
s_mov_b64 exec, 1
buffer_store_dword v7, v8, s[36:39], s61 offen sc0 sc1
s_mov_b64 exec, -1
L_cvx_19:
s_endpgm
L_A_gemm:
s_setprio 1
s_mov_b32 s44, s24
s_and_b32 s45, s25, 0xffff
s_mov_b32 s46, 1966080
s_mov_b32 s47, 0x00020000
s_and_b32 s53, s2, 255
s_and_b32 s54, s53, 7
s_lshr_b32 s55, s53, 3
s_and_b32 s56, s54, 3
s_lshl_b32 s56, s56, 2
s_lshr_b32 s57, s55, 3
s_add_u32 s56, s56, s57
s_lshr_b32 s57, s54, 2
s_lshl_b32 s57, s57, 3
s_and_b32 s58, s55, 7
s_add_u32 s57, s57, s58
s_lshl_b32 s60, s56, 7
s_lshl_b32 s61, s52, 5
s_add_u32 s60, s60, s61
s_mul_i32 s61, s60, 1280
v_lshrrev_b32 v11, 3, v1
v_mul_u32_u24 v2, 1280, v11
v_and_b32 v12, 7, v1
v_lshlrev_b32 v13, 4, v12
v_add_u32 v2, v2, v13
v_add_u32 v2, s61, v2
s_and_b32 s70, s56, 3
s_mul_i32 s70, s70, 3
s_and_b32 s71, s57, 7
s_add_u32 s70, s70, s71
s_add_u32 s70, s70, s54
s_mul_i32 s71, s70, 6554
s_lshr_b32 s71, s71, 16
s_mul_i32 s71, s71, 10
s_sub_u32 s70, s70, s71
s_lshl_b32 s70, s70, 7
s_add_u32 s71, s70, 0
s_sub_u32 s72, s71, 1280
s_cmp_ge_u32 s71, 1280
s_cselect_b32 s80, s72, s71
s_add_u32 s71, s70, 128
s_sub_u32 s72, s71, 1280
s_cmp_ge_u32 s71, 1280
s_cselect_b32 s81, s72, s71
s_add_u32 s71, s70, 256
s_sub_u32 s72, s71, 1280
s_cmp_ge_u32 s71, 1280
s_cselect_b32 s82, s72, s71
s_add_u32 s71, s70, 384
s_sub_u32 s72, s71, 1280
s_cmp_ge_u32 s71, 1280
s_cselect_b32 s83, s72, s71
s_add_u32 s71, s70, 512
s_sub_u32 s72, s71, 1280
s_cmp_ge_u32 s71, 1280
s_cselect_b32 s84, s72, s71
s_add_u32 s71, s70, 640
s_sub_u32 s72, s71, 1280
s_cmp_ge_u32 s71, 1280
s_cselect_b32 s85, s72, s71
s_add_u32 s71, s70, 768
s_sub_u32 s72, s71, 1280
s_cmp_ge_u32 s71, 1280
s_cselect_b32 s86, s72, s71
s_add_u32 s71, s70, 896
s_sub_u32 s72, s71, 1280
s_cmp_ge_u32 s71, 1280
s_cselect_b32 s87, s72, s71
s_add_u32 s71, s70, 1024
s_sub_u32 s72, s71, 1280
s_cmp_ge_u32 s71, 1280
s_cselect_b32 s88, s72, s71
s_add_u32 s71, s70, 1152
s_sub_u32 s72, s71, 1280
s_cmp_ge_u32 s71, 1280
s_cselect_b32 s89, s72, s71
s_add_u32 s65, s80, 0
buffer_load_dwordx4 v[132:135], v2, s[40:43], s65 offen
s_add_u32 s65, s80, 10240
buffer_load_dwordx4 v[136:139], v2, s[40:43], s65 offen
s_add_u32 s65, s80, 20480
buffer_load_dwordx4 v[140:143], v2, s[40:43], s65 offen
s_add_u32 s65, s80, 30720
buffer_load_dwordx4 v[144:147], v2, s[40:43], s65 offen
s_mul_i32 s62, s57, 192
s_mul_i32 s63, s52, 49152
s_add_u32 s62, s62, s63
s_mul_i32 s64, s52, 3072
v_add_u32 v11, 0, v1
v_mul_u32_u24 v12, 5462, v11
v_lshrrev_b32 v12, 16, v12
v_mul_u32_u24 v13, 12, v12
v_sub_u32 v13, v11, v13
v_lshlrev_b32 v13, 4, v13
v_mul_u32_u24 v12, 3072, v12
v_add_u32 v12, v12, v13
v_add_u32 v5, s62, v12
v_add_u32 v11, 64, v1
v_mul_u32_u24 v12, 5462, v11
v_lshrrev_b32 v12, 16, v12
v_mul_u32_u24 v13, 12, v12
v_sub_u32 v13, v11, v13
v_lshlrev_b32 v13, 4, v13
v_mul_u32_u24 v12, 3072, v12
v_add_u32 v12, v12, v13
v_add_u32 v6, s62, v12
v_add_u32 v11, 128, v1
v_mul_u32_u24 v12, 5462, v11
v_lshrrev_b32 v12, 16, v12
v_mul_u32_u24 v13, 12, v12
v_sub_u32 v13, v11, v13
v_lshlrev_b32 v13, 4, v13
v_mul_u32_u24 v12, 3072, v12
v_add_u32 v12, v12, v13
v_add_u32 v7, s62, v12
s_mul_i32 s65, s80, 1536
s_add_u32 m0, s64, 0
s_nop 0
buffer_load_dwordx4 v5, s[44:47], s65 offen lds
s_mul_i32 s65, s80, 1536
s_add_u32 m0, s64, 1024
s_nop 0
buffer_load_dwordx4 v6, s[44:47], s65 offen lds
s_mul_i32 s65, s80, 1536
s_add_u32 m0, s64, 2048
s_nop 0
buffer_load_dwordx4 v7, s[44:47], s65 offen lds
s_lshl_b32 s66, s52, 13
s_add_u32 s66, s66, 49152
v_lshrrev_b32 v11, 3, v1
v_lshrrev_b32 v12, 1, v11
v_and_b32 v13, 7, v1
v_xor_b32 v12, v12, v13
v_lshlrev_b32 v12, 4, v12
v_lshlrev_b32 v11, 7, v11
s_add_u32 s65, s81, 0
buffer_load_dwordx4 v[148:151], v2, s[40:43], s65 offen
v_add_u32 v3, v11, v12
v_add_u32 v3, s66, v3
v_and_b32 v11, 31, v1
v_bfe_u32 v12, v1, 1, 3
v_lshrrev_b32 v13, 5, v1
v_xor_b32 v12, v12, v13
v_lshlrev_b32 v12, 4, v12
v_lshlrev_b32 v11, 7, v11
s_mul_i32 s65, s81, 1536
s_add_u32 m0, s64, 12288
s_nop 0
buffer_load_dwordx4 v5, s[44:47], s65 offen lds
v_add_u32 v4, v11, v12
v_add_u32 v4, s66, v4
s_cmp_eq_u32 s52, 3
s_cselect_b32 s67, 0, s52
s_add_u32 s68, s67, 1
s_cmp_eq_u32 s68, 3
s_cselect_b32 s68, 0, s68
s_add_u32 s69, s68, 1
s_add_u32 s65, s81, 10240
buffer_load_dwordx4 v[152:155], v2, s[40:43], s65 offen
s_cmp_eq_u32 s69, 3
s_cselect_b32 s69, 0, s69
v_lshrrev_b32 v11, 5, v1
v_lshlrev_b32 v11, 3, v11
v_bfe_u32 v12, v1, 2, 2
v_add_u32 v11, v11, v12
v_mul_u32_u24 v11, 192, v11
v_bfe_u32 v12, v1, 4, 1
s_mul_i32 s65, s81, 1536
s_add_u32 m0, s64, 13312
s_nop 0
buffer_load_dwordx4 v6, s[44:47], s65 offen lds
v_lshlrev_b32 v12, 5, v12
v_add_u32 v11, v11, v12
v_and_b32 v12, 3, v1
v_lshlrev_b32 v12, 3, v12
v_add_u32 v11, v11, v12
v_mov_b32 v15, 0
s_lshl_b32 s71, s67, 6
v_add_u32 v8, s71, v11
s_add_u32 s65, s81, 20480
buffer_load_dwordx4 v[156:159], v2, s[40:43], s65 offen
s_lshl_b32 s71, s68, 6
v_add_u32 v9, s71, v11
s_lshl_b32 s71, s69, 6
v_add_u32 v10, s71, v11
v_mov_b32 v16, 0x3f803f80
v_mov_b32 v17, 0x3f803f80
v_mov_b32 v18, 0x3f803f80
v_mov_b32 v19, 0x3f803f80
s_mul_i32 s65, s81, 1536
s_add_u32 m0, s64, 14336
s_nop 0
buffer_load_dwordx4 v7, s[44:47], s65 offen lds
v_mov_b32 v20, 0
v_mov_b32 v21, 0
v_mov_b32 v22, 0
v_mov_b32 v23, 0
v_mov_b32 v24, 0
v_mov_b32 v25, 0
v_mov_b32 v26, 0
v_mov_b32 v27, 0
s_add_u32 s65, s81, 30720
buffer_load_dwordx4 v[160:163], v2, s[40:43], s65 offen
v_mov_b32 v28, 0
v_mov_b32 v29, 0
v_mov_b32 v30, 0
v_mov_b32 v31, 0
v_mov_b32 v32, 0
v_mov_b32 v33, 0
v_mov_b32 v34, 0
v_mov_b32 v35, 0
s_add_u32 s65, s82, 0
buffer_load_dwordx4 v[164:167], v2, s[40:43], s65 offen
v_mov_b32 v36, 0
v_mov_b32 v37, 0
v_mov_b32 v38, 0
v_mov_b32 v39, 0
v_mov_b32 v40, 0
v_mov_b32 v41, 0
v_mov_b32 v42, 0
v_mov_b32 v43, 0
s_mul_i32 s65, s82, 1536
s_add_u32 m0, s64, 24576
s_nop 0
buffer_load_dwordx4 v5, s[44:47], s65 offen lds
v_mov_b32 v44, 0
v_mov_b32 v45, 0
v_mov_b32 v46, 0
v_mov_b32 v47, 0
v_mov_b32 v48, 0
v_mov_b32 v49, 0
v_mov_b32 v50, 0
v_mov_b32 v51, 0
s_add_u32 s65, s82, 10240
buffer_load_dwordx4 v[168:171], v2, s[40:43], s65 offen
v_mov_b32 v52, 0
v_mov_b32 v53, 0
v_mov_b32 v54, 0
v_mov_b32 v55, 0
v_mov_b32 v56, 0
v_mov_b32 v57, 0
v_mov_b32 v58, 0
v_mov_b32 v59, 0
s_mul_i32 s65, s82, 1536
s_add_u32 m0, s64, 25600
s_nop 0
buffer_load_dwordx4 v6, s[44:47], s65 offen lds
v_mov_b32 v60, 0
v_mov_b32 v61, 0
v_mov_b32 v62, 0
v_mov_b32 v63, 0
v_mov_b32 v64, 0
v_mov_b32 v65, 0
v_mov_b32 v66, 0
v_mov_b32 v67, 0
s_add_u32 s65, s82, 20480
buffer_load_dwordx4 v[172:175], v2, s[40:43], s65 offen
v_mov_b32 v68, 0
v_mov_b32 v69, 0
v_mov_b32 v70, 0
v_mov_b32 v71, 0
v_mov_b32 v72, 0
v_mov_b32 v73, 0
v_mov_b32 v74, 0
v_mov_b32 v75, 0
s_mul_i32 s65, s82, 1536
s_add_u32 m0, s64, 26624
s_nop 0
buffer_load_dwordx4 v7, s[44:47], s65 offen lds
v_mov_b32 v76, 0
v_mov_b32 v77, 0
v_mov_b32 v78, 0
v_mov_b32 v79, 0
v_mov_b32 v80, 0
v_mov_b32 v81, 0
v_mov_b32 v82, 0
v_mov_b32 v83, 0
s_add_u32 s65, s82, 30720
buffer_load_dwordx4 v[176:179], v2, s[40:43], s65 offen
v_xor_b32 v251, 64, v3
v_xor_b32 v252, 32, v4
v_xor_b32 v253, 64, v4
v_xor_b32 v254, 96, v4
s_waitcnt vmcnt(17)
ds_write_b128 v3, v[132:135] offset:0
ds_write_b128 v251, v[136:139] offset:1024
ds_write_b128 v3, v[140:143] offset:2048
ds_write_b128 v251, v[144:147] offset:3072
s_waitcnt vmcnt(14)
s_waitcnt lgkmcnt(0)
s_barrier
ds_read_b128 v[96:99], v4 offset:0
ds_read_b64_tr_b16 v[84:85], v8 offset:0
ds_read_b64_tr_b16 v[86:87], v8 offset:768
ds_read_b64_tr_b16 v[88:89], v9 offset:0
ds_read_b64_tr_b16 v[90:91], v9 offset:768
ds_read_b64_tr_b16 v[92:93], v10 offset:0
ds_read_b64_tr_b16 v[94:95], v10 offset:768
ds_read_b128 v[112:115], v252 offset:0
ds_read_b64_tr_b16 v[100:101], v8 offset:3072
ds_read_b64_tr_b16 v[102:103], v8 offset:3840
ds_read_b64_tr_b16 v[104:105], v9 offset:3072
ds_read_b64_tr_b16 v[106:107], v9 offset:3840
ds_read_b64_tr_b16 v[108:109], v10 offset:3072
ds_read_b64_tr_b16 v[110:111], v10 offset:3840
s_add_u32 s65, s83, 0
buffer_load_dwordx4 v[180:183], v2, s[40:43], s65 offen
s_mul_i32 s65, s83, 1536
s_add_u32 m0, s64, 36864
s_nop 0
buffer_load_dwordx4 v5, s[44:47], s65 offen lds
s_waitcnt lgkmcnt(7)
v_mfma_f32_32x32x16_bf16 v[20:35], v[84:87], v[96:99], v[20:35]
ds_read_b128 v[128:131], v253 offset:0
ds_read_b64_tr_b16 v[116:117], v8 offset:6144
v_mfma_f32_32x32x16_bf16 v[36:51], v[88:91], v[96:99], v[36:51]
ds_read_b64_tr_b16 v[118:119], v8 offset:6912
ds_read_b64_tr_b16 v[120:121], v9 offset:6144
s_add_u32 s65, s83, 10240
buffer_load_dwordx4 v[184:187], v2, s[40:43], s65 offen
v_mfma_f32_32x32x16_bf16 v[52:67], v[92:95], v[96:99], v[52:67]
ds_read_b64_tr_b16 v[122:123], v9 offset:6912
ds_read_b64_tr_b16 v[124:125], v10 offset:6144
s_mul_i32 s65, s83, 1536
s_add_u32 m0, s64, 37888
s_nop 0
buffer_load_dwordx4 v6, s[44:47], s65 offen lds
s_waitcnt vmcnt(11)
ds_write_b128 v3, v[148:151] offset:4096
v_mfma_f32_32x32x16_bf16 v[68:83], v[84:87], v[16:19], v[68:83]
ds_read_b64_tr_b16 v[126:127], v10 offset:6912
ds_write_b128 v251, v[152:155] offset:5120
s_waitcnt lgkmcnt(9)
v_mfma_f32_32x32x16_bf16 v[20:35], v[100:103], v[112:115], v[20:35]
ds_read_b128 v[96:99], v254 offset:0
ds_read_b64_tr_b16 v[84:85], v8 offset:9216
v_mfma_f32_32x32x16_bf16 v[36:51], v[104:107], v[112:115], v[36:51]
ds_read_b64_tr_b16 v[86:87], v8 offset:9984
ds_read_b64_tr_b16 v[88:89], v9 offset:9216
s_add_u32 s65, s83, 20480
buffer_load_dwordx4 v[188:191], v2, s[40:43], s65 offen
v_mfma_f32_32x32x16_bf16 v[52:67], v[108:111], v[112:115], v[52:67]
ds_read_b64_tr_b16 v[90:91], v9 offset:9984
ds_read_b64_tr_b16 v[92:93], v10 offset:9216
s_mul_i32 s65, s83, 1536
s_add_u32 m0, s64, 38912
s_nop 0
buffer_load_dwordx4 v7, s[44:47], s65 offen lds
ds_write_b128 v3, v[156:159] offset:6144
v_mfma_f32_32x32x16_bf16 v[68:83], v[100:103], v[16:19], v[68:83]
ds_read_b64_tr_b16 v[94:95], v10 offset:9984
ds_write_b128 v251, v[160:163] offset:7168
s_waitcnt lgkmcnt(9)
v_mfma_f32_32x32x16_bf16 v[20:35], v[116:119], v[128:131], v[20:35]
s_add_u32 s65, s83, 30720
buffer_load_dwordx4 v[192:195], v2, s[40:43], s65 offen
v_mfma_f32_32x32x16_bf16 v[36:51], v[120:123], v[128:131], v[36:51]
s_waitcnt lgkmcnt(0)
s_barrier
ds_read_b128 v[112:115], v4 offset:4096
ds_read_b64_tr_b16 v[100:101], v8 offset:12288
ds_read_b64_tr_b16 v[102:103], v8 offset:13056
v_mfma_f32_32x32x16_bf16 v[52:67], v[124:127], v[128:131], v[52:67]
ds_read_b64_tr_b16 v[104:105], v9 offset:12288
ds_read_b64_tr_b16 v[106:107], v9 offset:13056
ds_read_b64_tr_b16 v[108:109], v10 offset:12288
s_add_u32 s65, s84, 0
buffer_load_dwordx4 v[196:199], v2, s[40:43], s65 offen
v_mfma_f32_32x32x16_bf16 v[68:83], v[116:119], v[16:19], v[68:83]
ds_read_b64_tr_b16 v[110:111], v10 offset:13056
s_waitcnt vmcnt(8)
ds_write_b128 v3, v[164:167] offset:0
s_waitcnt lgkmcnt(8)
v_mfma_f32_32x32x16_bf16 v[20:35], v[84:87], v[96:99], v[20:35]
ds_read_b128 v[128:131], v252 offset:4096
ds_read_b64_tr_b16 v[116:117], v8 offset:15360
v_mfma_f32_32x32x16_bf16 v[36:51], v[88:91], v[96:99], v[36:51]
ds_read_b64_tr_b16 v[118:119], v8 offset:16128
ds_read_b64_tr_b16 v[120:121], v9 offset:15360
s_mul_i32 s65, s84, 1536
s_add_u32 m0, s64, 0
s_nop 0
buffer_load_dwordx4 v5, s[44:47], s65 offen lds
v_mfma_f32_32x32x16_bf16 v[52:67], v[92:95], v[96:99], v[52:67]
ds_read_b64_tr_b16 v[122:123], v9 offset:16128
ds_read_b64_tr_b16 v[124:125], v10 offset:15360
s_add_u32 s65, s84, 10240
buffer_load_dwordx4 v[200:203], v2, s[40:43], s65 offen
v_mfma_f32_32x32x16_bf16 v[68:83], v[84:87], v[16:19], v[68:83]
ds_read_b64_tr_b16 v[126:127], v10 offset:16128
ds_write_b128 v251, v[168:171] offset:1024
s_waitcnt lgkmcnt(8)
v_mfma_f32_32x32x16_bf16 v[20:35], v[100:103], v[112:115], v[20:35]
ds_read_b128 v[96:99], v253 offset:4096
ds_read_b64_tr_b16 v[84:85], v8 offset:18432
v_mfma_f32_32x32x16_bf16 v[36:51], v[104:107], v[112:115], v[36:51]
ds_read_b64_tr_b16 v[86:87], v8 offset:19200
ds_read_b64_tr_b16 v[88:89], v9 offset:18432
s_mul_i32 s65, s84, 1536
s_add_u32 m0, s64, 1024
s_nop 0
buffer_load_dwordx4 v6, s[44:47], s65 offen lds
v_mfma_f32_32x32x16_bf16 v[52:67], v[108:111], v[112:115], v[52:67]
ds_read_b64_tr_b16 v[90:91], v9 offset:19200
ds_read_b64_tr_b16 v[92:93], v10 offset:18432
s_add_u32 s65, s84, 20480
buffer_load_dwordx4 v[204:207], v2, s[40:43], s65 offen
v_mfma_f32_32x32x16_bf16 v[68:83], v[100:103], v[16:19], v[68:83]
ds_read_b64_tr_b16 v[94:95], v10 offset:19200
ds_write_b128 v3, v[172:175] offset:2048
s_waitcnt lgkmcnt(8)
v_mfma_f32_32x32x16_bf16 v[20:35], v[116:119], v[128:131], v[20:35]
ds_read_b128 v[112:115], v254 offset:4096
ds_read_b64_tr_b16 v[100:101], v8 offset:21504
v_mfma_f32_32x32x16_bf16 v[36:51], v[120:123], v[128:131], v[36:51]
ds_read_b64_tr_b16 v[102:103], v8 offset:22272
ds_read_b64_tr_b16 v[104:105], v9 offset:21504
s_mul_i32 s65, s84, 1536
s_add_u32 m0, s64, 2048
s_nop 0
buffer_load_dwordx4 v7, s[44:47], s65 offen lds
v_mfma_f32_32x32x16_bf16 v[52:67], v[124:127], v[128:131], v[52:67]
ds_read_b64_tr_b16 v[106:107], v9 offset:22272
ds_read_b64_tr_b16 v[108:109], v10 offset:21504
s_add_u32 s65, s84, 30720
buffer_load_dwordx4 v[208:211], v2, s[40:43], s65 offen
v_mfma_f32_32x32x16_bf16 v[68:83], v[116:119], v[16:19], v[68:83]
ds_read_b64_tr_b16 v[110:111], v10 offset:22272
ds_write_b128 v251, v[176:179] offset:3072
s_waitcnt lgkmcnt(8)
v_mfma_f32_32x32x16_bf16 v[20:35], v[84:87], v[96:99], v[20:35]
s_add_u32 s65, s85, 0
buffer_load_dwordx4 v[212:215], v2, s[40:43], s65 offen
v_mfma_f32_32x32x16_bf16 v[36:51], v[88:91], v[96:99], v[36:51]
s_waitcnt lgkmcnt(0)
s_barrier
ds_read_b128 v[128:131], v4 offset:0
ds_read_b64_tr_b16 v[116:117], v8 offset:24576
ds_read_b64_tr_b16 v[118:119], v8 offset:25344
v_mfma_f32_32x32x16_bf16 v[52:67], v[92:95], v[96:99], v[52:67]
ds_read_b64_tr_b16 v[120:121], v9 offset:24576
ds_read_b64_tr_b16 v[122:123], v9 offset:25344
ds_read_b64_tr_b16 v[124:125], v10 offset:24576
s_mul_i32 s65, s85, 1536
s_add_u32 m0, s64, 12288
s_nop 0
buffer_load_dwordx4 v5, s[44:47], s65 offen lds
v_mfma_f32_32x32x16_bf16 v[68:83], v[84:87], v[16:19], v[68:83]
ds_read_b64_tr_b16 v[126:127], v10 offset:25344
s_waitcnt vmcnt(9)
ds_write_b128 v3, v[180:183] offset:4096
s_waitcnt lgkmcnt(8)
v_mfma_f32_32x32x16_bf16 v[20:35], v[100:103], v[112:115], v[20:35]
ds_read_b128 v[96:99], v252 offset:0
ds_read_b64_tr_b16 v[84:85], v8 offset:27648
v_mfma_f32_32x32x16_bf16 v[36:51], v[104:107], v[112:115], v[36:51]
ds_read_b64_tr_b16 v[86:87], v8 offset:28416
ds_read_b64_tr_b16 v[88:89], v9 offset:27648
s_add_u32 s65, s85, 10240
buffer_load_dwordx4 v[216:219], v2, s[40:43], s65 offen
v_mfma_f32_32x32x16_bf16 v[52:67], v[108:111], v[112:115], v[52:67]
ds_read_b64_tr_b16 v[90:91], v9 offset:28416
ds_read_b64_tr_b16 v[92:93], v10 offset:27648
s_mul_i32 s65, s85, 1536
s_add_u32 m0, s64, 13312
s_nop 0
buffer_load_dwordx4 v6, s[44:47], s65 offen lds
v_mfma_f32_32x32x16_bf16 v[68:83], v[100:103], v[16:19], v[68:83]
ds_read_b64_tr_b16 v[94:95], v10 offset:28416
ds_write_b128 v251, v[184:187] offset:5120
s_waitcnt lgkmcnt(8)
v_mfma_f32_32x32x16_bf16 v[20:35], v[116:119], v[128:131], v[20:35]
ds_read_b128 v[112:115], v253 offset:0
ds_read_b64_tr_b16 v[100:101], v8 offset:30720
v_mfma_f32_32x32x16_bf16 v[36:51], v[120:123], v[128:131], v[36:51]
ds_read_b64_tr_b16 v[102:103], v8 offset:31488
ds_read_b64_tr_b16 v[104:105], v9 offset:30720
s_add_u32 s65, s85, 20480
buffer_load_dwordx4 v[220:223], v2, s[40:43], s65 offen
v_mfma_f32_32x32x16_bf16 v[52:67], v[124:127], v[128:131], v[52:67]
ds_read_b64_tr_b16 v[106:107], v9 offset:31488
ds_read_b64_tr_b16 v[108:109], v10 offset:30720
s_mul_i32 s65, s85, 1536
s_add_u32 m0, s64, 14336
s_nop 0
buffer_load_dwordx4 v7, s[44:47], s65 offen lds
v_mfma_f32_32x32x16_bf16 v[68:83], v[116:119], v[16:19], v[68:83]
ds_read_b64_tr_b16 v[110:111], v10 offset:31488
ds_write_b128 v3, v[188:191] offset:6144
s_waitcnt lgkmcnt(8)
v_mfma_f32_32x32x16_bf16 v[20:35], v[84:87], v[96:99], v[20:35]
ds_read_b128 v[128:131], v254 offset:0
ds_read_b64_tr_b16 v[116:117], v8 offset:33792
v_mfma_f32_32x32x16_bf16 v[36:51], v[88:91], v[96:99], v[36:51]
ds_read_b64_tr_b16 v[118:119], v8 offset:34560
ds_read_b64_tr_b16 v[120:121], v9 offset:33792
s_add_u32 s65, s85, 30720
buffer_load_dwordx4 v[224:227], v2, s[40:43], s65 offen
v_mfma_f32_32x32x16_bf16 v[52:67], v[92:95], v[96:99], v[52:67]
ds_read_b64_tr_b16 v[122:123], v9 offset:34560
ds_read_b64_tr_b16 v[124:125], v10 offset:33792
s_add_u32 s65, s86, 0
buffer_load_dwordx4 v[228:231], v2, s[40:43], s65 offen
v_mfma_f32_32x32x16_bf16 v[68:83], v[84:87], v[16:19], v[68:83]
ds_read_b64_tr_b16 v[126:127], v10 offset:34560
ds_write_b128 v251, v[192:195] offset:7168
s_waitcnt lgkmcnt(8)
v_mfma_f32_32x32x16_bf16 v[20:35], v[100:103], v[112:115], v[20:35]
s_add_u32 s65, s86, 10240
buffer_load_dwordx4 v[232:235], v2, s[40:43], s65 offen
v_mfma_f32_32x32x16_bf16 v[36:51], v[104:107], v[112:115], v[36:51]
s_waitcnt lgkmcnt(0)
s_barrier
ds_read_b128 v[96:99], v4 offset:4096
ds_read_b64_tr_b16 v[84:85], v8 offset:36864
ds_read_b64_tr_b16 v[86:87], v8 offset:37632
v_mfma_f32_32x32x16_bf16 v[52:67], v[108:111], v[112:115], v[52:67]
ds_read_b64_tr_b16 v[88:89], v9 offset:36864
ds_read_b64_tr_b16 v[90:91], v9 offset:37632
ds_read_b64_tr_b16 v[92:93], v10 offset:36864
s_mul_i32 s65, s86, 1536
s_add_u32 m0, s64, 24576
s_nop 0
buffer_load_dwordx4 v5, s[44:47], s65 offen lds
v_mfma_f32_32x32x16_bf16 v[68:83], v[100:103], v[16:19], v[68:83]
ds_read_b64_tr_b16 v[94:95], v10 offset:37632
s_waitcnt vmcnt(10)
ds_write_b128 v3, v[196:199] offset:0
s_waitcnt lgkmcnt(8)
v_mfma_f32_32x32x16_bf16 v[20:35], v[116:119], v[128:131], v[20:35]
ds_read_b128 v[112:115], v252 offset:4096
ds_read_b64_tr_b16 v[100:101], v8 offset:39936
v_mfma_f32_32x32x16_bf16 v[36:51], v[120:123], v[128:131], v[36:51]
ds_read_b64_tr_b16 v[102:103], v8 offset:40704
ds_read_b64_tr_b16 v[104:105], v9 offset:39936
s_mul_i32 s65, s86, 1536
s_add_u32 m0, s64, 25600
s_nop 0
buffer_load_dwordx4 v6, s[44:47], s65 offen lds
v_mfma_f32_32x32x16_bf16 v[52:67], v[124:127], v[128:131], v[52:67]
ds_read_b64_tr_b16 v[106:107], v9 offset:40704
ds_read_b64_tr_b16 v[108:109], v10 offset:39936
s_add_u32 s65, s86, 20480
buffer_load_dwordx4 v[236:239], v2, s[40:43], s65 offen
v_mfma_f32_32x32x16_bf16 v[68:83], v[116:119], v[16:19], v[68:83]
ds_read_b64_tr_b16 v[110:111], v10 offset:40704
ds_write_b128 v251, v[200:203] offset:1024
s_waitcnt lgkmcnt(8)
v_mfma_f32_32x32x16_bf16 v[20:35], v[84:87], v[96:99], v[20:35]
ds_read_b128 v[128:131], v253 offset:4096
ds_read_b64_tr_b16 v[116:117], v8 offset:43008
v_mfma_f32_32x32x16_bf16 v[36:51], v[88:91], v[96:99], v[36:51]
ds_read_b64_tr_b16 v[118:119], v8 offset:43776
ds_read_b64_tr_b16 v[120:121], v9 offset:43008
s_mul_i32 s65, s86, 1536
s_add_u32 m0, s64, 26624
s_nop 0
buffer_load_dwordx4 v7, s[44:47], s65 offen lds
v_mfma_f32_32x32x16_bf16 v[52:67], v[92:95], v[96:99], v[52:67]
ds_read_b64_tr_b16 v[122:123], v9 offset:43776
ds_read_b64_tr_b16 v[124:125], v10 offset:43008
s_add_u32 s65, s86, 30720
buffer_load_dwordx4 v[240:243], v2, s[40:43], s65 offen
v_mfma_f32_32x32x16_bf16 v[68:83], v[84:87], v[16:19], v[68:83]
ds_read_b64_tr_b16 v[126:127], v10 offset:43776
ds_write_b128 v3, v[204:207] offset:2048
s_waitcnt lgkmcnt(8)
v_mfma_f32_32x32x16_bf16 v[20:35], v[100:103], v[112:115], v[20:35]
ds_read_b128 v[96:99], v254 offset:4096
ds_read_b64_tr_b16 v[84:85], v8 offset:46080
v_mfma_f32_32x32x16_bf16 v[36:51], v[104:107], v[112:115], v[36:51]
ds_read_b64_tr_b16 v[86:87], v8 offset:46848
ds_read_b64_tr_b16 v[88:89], v9 offset:46080
s_add_u32 s65, s87, 0
buffer_load_dwordx4 v[132:135], v2, s[40:43], s65 offen
v_mfma_f32_32x32x16_bf16 v[52:67], v[108:111], v[112:115], v[52:67]
ds_read_b64_tr_b16 v[90:91], v9 offset:46848
ds_read_b64_tr_b16 v[92:93], v10 offset:46080
s_add_u32 s65, s87, 10240
buffer_load_dwordx4 v[136:139], v2, s[40:43], s65 offen
v_mfma_f32_32x32x16_bf16 v[68:83], v[100:103], v[16:19], v[68:83]
ds_read_b64_tr_b16 v[94:95], v10 offset:46848
ds_write_b128 v251, v[208:211] offset:3072
s_waitcnt lgkmcnt(8)
v_mfma_f32_32x32x16_bf16 v[20:35], v[116:119], v[128:131], v[20:35]
s_add_u32 s65, s87, 20480
buffer_load_dwordx4 v[140:143], v2, s[40:43], s65 offen
v_mfma_f32_32x32x16_bf16 v[36:51], v[120:123], v[128:131], v[36:51]
s_waitcnt lgkmcnt(0)
s_barrier
ds_read_b128 v[112:115], v4 offset:0
ds_read_b64_tr_b16 v[100:101], v8 offset:0
ds_read_b64_tr_b16 v[102:103], v8 offset:768
v_mfma_f32_32x32x16_bf16 v[52:67], v[124:127], v[128:131], v[52:67]
ds_read_b64_tr_b16 v[104:105], v9 offset:0
ds_read_b64_tr_b16 v[106:107], v9 offset:768
ds_read_b64_tr_b16 v[108:109], v10 offset:0
s_mul_i32 s65, s87, 1536
s_add_u32 m0, s64, 36864
s_nop 0
buffer_load_dwordx4 v5, s[44:47], s65 offen lds
v_mfma_f32_32x32x16_bf16 v[68:83], v[116:119], v[16:19], v[68:83]
ds_read_b64_tr_b16 v[110:111], v10 offset:768
s_waitcnt vmcnt(11)
ds_write_b128 v3, v[212:215] offset:4096
s_waitcnt lgkmcnt(8)
v_mfma_f32_32x32x16_bf16 v[20:35], v[84:87], v[96:99], v[20:35]
ds_read_b128 v[128:131], v252 offset:0
ds_read_b64_tr_b16 v[116:117], v8 offset:3072
v_mfma_f32_32x32x16_bf16 v[36:51], v[88:91], v[96:99], v[36:51]
ds_read_b64_tr_b16 v[118:119], v8 offset:3840
ds_read_b64_tr_b16 v[120:121], v9 offset:3072
s_mul_i32 s65, s87, 1536
s_add_u32 m0, s64, 37888
s_nop 0
buffer_load_dwordx4 v6, s[44:47], s65 offen lds
v_mfma_f32_32x32x16_bf16 v[52:67], v[92:95], v[96:99], v[52:67]
ds_read_b64_tr_b16 v[122:123], v9 offset:3840
ds_read_b64_tr_b16 v[124:125], v10 offset:3072
s_mul_i32 s65, s87, 1536
s_add_u32 m0, s64, 38912
s_nop 0
buffer_load_dwordx4 v7, s[44:47], s65 offen lds
v_mfma_f32_32x32x16_bf16 v[68:83], v[84:87], v[16:19], v[68:83]
ds_read_b64_tr_b16 v[126:127], v10 offset:3840
ds_write_b128 v251, v[216:219] offset:5120
s_waitcnt lgkmcnt(8)
v_mfma_f32_32x32x16_bf16 v[20:35], v[100:103], v[112:115], v[20:35]
ds_read_b128 v[96:99], v253 offset:0
ds_read_b64_tr_b16 v[84:85], v8 offset:6144
v_mfma_f32_32x32x16_bf16 v[36:51], v[104:107], v[112:115], v[36:51]
ds_read_b64_tr_b16 v[86:87], v8 offset:6912
ds_read_b64_tr_b16 v[88:89], v9 offset:6144
s_add_u32 s65, s87, 30720
buffer_load_dwordx4 v[144:147], v2, s[40:43], s65 offen
v_mfma_f32_32x32x16_bf16 v[52:67], v[108:111], v[112:115], v[52:67]
ds_read_b64_tr_b16 v[90:91], v9 offset:6912
ds_read_b64_tr_b16 v[92:93], v10 offset:6144
s_add_u32 s65, s88, 0
buffer_load_dwordx4 v[148:151], v2, s[40:43], s65 offen
v_mfma_f32_32x32x16_bf16 v[68:83], v[100:103], v[16:19], v[68:83]
ds_read_b64_tr_b16 v[94:95], v10 offset:6912
ds_write_b128 v3, v[220:223] offset:6144
s_waitcnt lgkmcnt(8)
v_mfma_f32_32x32x16_bf16 v[20:35], v[116:119], v[128:131], v[20:35]
ds_read_b128 v[112:115], v254 offset:0
ds_read_b64_tr_b16 v[100:101], v8 offset:9216
v_mfma_f32_32x32x16_bf16 v[36:51], v[120:123], v[128:131], v[36:51]
ds_read_b64_tr_b16 v[102:103], v8 offset:9984
ds_read_b64_tr_b16 v[104:105], v9 offset:9216
s_add_u32 s65, s88, 10240
buffer_load_dwordx4 v[152:155], v2, s[40:43], s65 offen
v_mfma_f32_32x32x16_bf16 v[52:67], v[124:127], v[128:131], v[52:67]
ds_read_b64_tr_b16 v[106:107], v9 offset:9984
ds_read_b64_tr_b16 v[108:109], v10 offset:9216
s_add_u32 s65, s88, 20480
buffer_load_dwordx4 v[156:159], v2, s[40:43], s65 offen
v_mfma_f32_32x32x16_bf16 v[68:83], v[116:119], v[16:19], v[68:83]
ds_read_b64_tr_b16 v[110:111], v10 offset:9984
ds_write_b128 v251, v[224:227] offset:7168
s_waitcnt lgkmcnt(8)
v_mfma_f32_32x32x16_bf16 v[20:35], v[84:87], v[96:99], v[20:35]
s_add_u32 s65, s88, 30720
buffer_load_dwordx4 v[160:163], v2, s[40:43], s65 offen
v_mfma_f32_32x32x16_bf16 v[36:51], v[88:91], v[96:99], v[36:51]
s_waitcnt lgkmcnt(0)
s_barrier
ds_read_b128 v[128:131], v4 offset:4096
ds_read_b64_tr_b16 v[116:117], v8 offset:12288
ds_read_b64_tr_b16 v[118:119], v8 offset:13056
v_mfma_f32_32x32x16_bf16 v[52:67], v[92:95], v[96:99], v[52:67]
ds_read_b64_tr_b16 v[120:121], v9 offset:12288
ds_read_b64_tr_b16 v[122:123], v9 offset:13056
ds_read_b64_tr_b16 v[124:125], v10 offset:12288
s_mul_i32 s65, s88, 1536
s_add_u32 m0, s64, 0
s_nop 0
buffer_load_dwordx4 v5, s[44:47], s65 offen lds
v_mfma_f32_32x32x16_bf16 v[68:83], v[84:87], v[16:19], v[68:83]
ds_read_b64_tr_b16 v[126:127], v10 offset:13056
s_waitcnt vmcnt(12)
ds_write_b128 v3, v[228:231] offset:0
s_waitcnt lgkmcnt(8)
v_mfma_f32_32x32x16_bf16 v[20:35], v[100:103], v[112:115], v[20:35]
ds_read_b128 v[96:99], v252 offset:4096
ds_read_b64_tr_b16 v[84:85], v8 offset:15360
v_mfma_f32_32x32x16_bf16 v[36:51], v[104:107], v[112:115], v[36:51]
ds_read_b64_tr_b16 v[86:87], v8 offset:16128
ds_read_b64_tr_b16 v[88:89], v9 offset:15360
s_mul_i32 s65, s88, 1536
s_add_u32 m0, s64, 1024
s_nop 0
buffer_load_dwordx4 v6, s[44:47], s65 offen lds
v_mfma_f32_32x32x16_bf16 v[52:67], v[108:111], v[112:115], v[52:67]
ds_read_b64_tr_b16 v[90:91], v9 offset:16128
ds_read_b64_tr_b16 v[92:93], v10 offset:15360
s_mul_i32 s65, s88, 1536
s_add_u32 m0, s64, 2048
s_nop 0
buffer_load_dwordx4 v7, s[44:47], s65 offen lds
v_mfma_f32_32x32x16_bf16 v[68:83], v[100:103], v[16:19], v[68:83]
ds_read_b64_tr_b16 v[94:95], v10 offset:16128
ds_write_b128 v251, v[232:235] offset:1024
s_waitcnt lgkmcnt(8)
v_mfma_f32_32x32x16_bf16 v[20:35], v[116:119], v[128:131], v[20:35]
ds_read_b128 v[112:115], v253 offset:4096
ds_read_b64_tr_b16 v[100:101], v8 offset:18432
v_mfma_f32_32x32x16_bf16 v[36:51], v[120:123], v[128:131], v[36:51]
ds_read_b64_tr_b16 v[102:103], v8 offset:19200
ds_read_b64_tr_b16 v[104:105], v9 offset:18432
s_add_u32 s65, s89, 0
buffer_load_dwordx4 v[164:167], v2, s[40:43], s65 offen
v_mfma_f32_32x32x16_bf16 v[52:67], v[124:127], v[128:131], v[52:67]
ds_read_b64_tr_b16 v[106:107], v9 offset:19200
ds_read_b64_tr_b16 v[108:109], v10 offset:18432
s_add_u32 s65, s89, 10240
buffer_load_dwordx4 v[168:171], v2, s[40:43], s65 offen
v_mfma_f32_32x32x16_bf16 v[68:83], v[116:119], v[16:19], v[68:83]
ds_read_b64_tr_b16 v[110:111], v10 offset:19200
ds_write_b128 v3, v[236:239] offset:2048
s_waitcnt lgkmcnt(8)
v_mfma_f32_32x32x16_bf16 v[20:35], v[84:87], v[96:99], v[20:35]
ds_read_b128 v[128:131], v254 offset:4096
ds_read_b64_tr_b16 v[116:117], v8 offset:21504
v_mfma_f32_32x32x16_bf16 v[36:51], v[88:91], v[96:99], v[36:51]
ds_read_b64_tr_b16 v[118:119], v8 offset:22272
ds_read_b64_tr_b16 v[120:121], v9 offset:21504
s_add_u32 s65, s89, 20480
buffer_load_dwordx4 v[172:175], v2, s[40:43], s65 offen
v_mfma_f32_32x32x16_bf16 v[52:67], v[92:95], v[96:99], v[52:67]
ds_read_b64_tr_b16 v[122:123], v9 offset:22272
ds_read_b64_tr_b16 v[124:125], v10 offset:21504
s_add_u32 s65, s89, 30720
buffer_load_dwordx4 v[176:179], v2, s[40:43], s65 offen
v_mfma_f32_32x32x16_bf16 v[68:83], v[84:87], v[16:19], v[68:83]
ds_read_b64_tr_b16 v[126:127], v10 offset:22272
ds_write_b128 v251, v[240:243] offset:3072
s_waitcnt lgkmcnt(8)
v_mfma_f32_32x32x16_bf16 v[20:35], v[100:103], v[112:115], v[20:35]
v_mfma_f32_32x32x16_bf16 v[36:51], v[104:107], v[112:115], v[36:51]
s_waitcnt lgkmcnt(0)
s_barrier
ds_read_b128 v[96:99], v4 offset:0
ds_read_b64_tr_b16 v[84:85], v8 offset:24576
ds_read_b64_tr_b16 v[86:87], v8 offset:25344
v_mfma_f32_32x32x16_bf16 v[52:67], v[108:111], v[112:115], v[52:67]
ds_read_b64_tr_b16 v[88:89], v9 offset:24576
ds_read_b64_tr_b16 v[90:91], v9 offset:25344
ds_read_b64_tr_b16 v[92:93], v10 offset:24576
s_mul_i32 s65, s89, 1536
s_add_u32 m0, s64, 12288
s_nop 0
buffer_load_dwordx4 v5, s[44:47], s65 offen lds
v_mfma_f32_32x32x16_bf16 v[68:83], v[100:103], v[16:19], v[68:83]
ds_read_b64_tr_b16 v[94:95], v10 offset:25344
s_waitcnt vmcnt(12)
ds_write_b128 v3, v[132:135] offset:4096
s_waitcnt lgkmcnt(8)
v_mfma_f32_32x32x16_bf16 v[20:35], v[116:119], v[128:131], v[20:35]
ds_read_b128 v[112:115], v252 offset:0
ds_read_b64_tr_b16 v[100:101], v8 offset:27648
v_mfma_f32_32x32x16_bf16 v[36:51], v[120:123], v[128:131], v[36:51]
ds_read_b64_tr_b16 v[102:103], v8 offset:28416
ds_read_b64_tr_b16 v[104:105], v9 offset:27648
s_mul_i32 s65, s89, 1536
s_add_u32 m0, s64, 13312
s_nop 0
buffer_load_dwordx4 v6, s[44:47], s65 offen lds
v_mfma_f32_32x32x16_bf16 v[52:67], v[124:127], v[128:131], v[52:67]
ds_read_b64_tr_b16 v[106:107], v9 offset:28416
ds_read_b64_tr_b16 v[108:109], v10 offset:27648
s_mul_i32 s65, s89, 1536
s_add_u32 m0, s64, 14336
s_nop 0
buffer_load_dwordx4 v7, s[44:47], s65 offen lds
v_mfma_f32_32x32x16_bf16 v[68:83], v[116:119], v[16:19], v[68:83]
ds_read_b64_tr_b16 v[110:111], v10 offset:28416
ds_write_b128 v251, v[136:139] offset:5120
s_waitcnt lgkmcnt(8)
v_mfma_f32_32x32x16_bf16 v[20:35], v[84:87], v[96:99], v[20:35]
ds_read_b128 v[128:131], v253 offset:0
ds_read_b64_tr_b16 v[116:117], v8 offset:30720
v_mfma_f32_32x32x16_bf16 v[36:51], v[88:91], v[96:99], v[36:51]
ds_read_b64_tr_b16 v[118:119], v8 offset:31488
ds_read_b64_tr_b16 v[120:121], v9 offset:30720
v_mfma_f32_32x32x16_bf16 v[52:67], v[92:95], v[96:99], v[52:67]
ds_read_b64_tr_b16 v[122:123], v9 offset:31488
ds_read_b64_tr_b16 v[124:125], v10 offset:30720
v_mfma_f32_32x32x16_bf16 v[68:83], v[84:87], v[16:19], v[68:83]
ds_read_b64_tr_b16 v[126:127], v10 offset:31488
ds_write_b128 v3, v[140:143] offset:6144
buffer_load_dword v244, v15, s[48:51], 0 offen sc0 sc1
v_min_u32 v11, 47, v1
v_lshlrev_b32 v11, 2, v11
s_mul_i32 s70, s57, 192
v_add_u32 v11, s70, v11
global_load_dword v250, v11, s[26:27]
s_waitcnt lgkmcnt(8)
v_mfma_f32_32x32x16_bf16 v[20:35], v[100:103], v[112:115], v[20:35]
ds_read_b128 v[96:99], v254 offset:0
ds_read_b64_tr_b16 v[84:85], v8 offset:33792
v_mfma_f32_32x32x16_bf16 v[36:51], v[104:107], v[112:115], v[36:51]
ds_read_b64_tr_b16 v[86:87], v8 offset:34560
ds_read_b64_tr_b16 v[88:89], v9 offset:33792
v_mfma_f32_32x32x16_bf16 v[52:67], v[108:111], v[112:115], v[52:67]
ds_read_b64_tr_b16 v[90:91], v9 offset:34560
ds_read_b64_tr_b16 v[92:93], v10 offset:33792
v_mfma_f32_32x32x16_bf16 v[68:83], v[100:103], v[16:19], v[68:83]
ds_read_b64_tr_b16 v[94:95], v10 offset:34560
ds_write_b128 v251, v[144:147] offset:7168
s_waitcnt lgkmcnt(8)
v_mfma_f32_32x32x16_bf16 v[20:35], v[116:119], v[128:131], v[20:35]
v_mfma_f32_32x32x16_bf16 v[36:51], v[120:123], v[128:131], v[36:51]
s_waitcnt lgkmcnt(0)
s_barrier
ds_read_b128 v[112:115], v4 offset:4096
ds_read_b64_tr_b16 v[100:101], v8 offset:36864
ds_read_b64_tr_b16 v[102:103], v8 offset:37632
v_mfma_f32_32x32x16_bf16 v[52:67], v[124:127], v[128:131], v[52:67]
ds_read_b64_tr_b16 v[104:105], v9 offset:36864
ds_read_b64_tr_b16 v[106:107], v9 offset:37632
ds_read_b64_tr_b16 v[108:109], v10 offset:36864
v_mfma_f32_32x32x16_bf16 v[68:83], v[116:119], v[16:19], v[68:83]
ds_read_b64_tr_b16 v[110:111], v10 offset:37632
s_waitcnt vmcnt(12)
ds_write_b128 v3, v[148:151] offset:0
s_waitcnt lgkmcnt(8)
v_mfma_f32_32x32x16_bf16 v[20:35], v[84:87], v[96:99], v[20:35]
ds_read_b128 v[128:131], v252 offset:4096
ds_read_b64_tr_b16 v[116:117], v8 offset:39936
v_mfma_f32_32x32x16_bf16 v[36:51], v[88:91], v[96:99], v[36:51]
ds_read_b64_tr_b16 v[118:119], v8 offset:40704
ds_read_b64_tr_b16 v[120:121], v9 offset:39936
v_mfma_f32_32x32x16_bf16 v[52:67], v[92:95], v[96:99], v[52:67]
ds_read_b64_tr_b16 v[122:123], v9 offset:40704
ds_read_b64_tr_b16 v[124:125], v10 offset:39936
v_mfma_f32_32x32x16_bf16 v[68:83], v[84:87], v[16:19], v[68:83]
ds_read_b64_tr_b16 v[126:127], v10 offset:40704
ds_write_b128 v251, v[152:155] offset:1024
s_waitcnt lgkmcnt(8)
v_mfma_f32_32x32x16_bf16 v[20:35], v[100:103], v[112:115], v[20:35]
ds_read_b128 v[96:99], v253 offset:4096
ds_read_b64_tr_b16 v[84:85], v8 offset:43008
v_mfma_f32_32x32x16_bf16 v[36:51], v[104:107], v[112:115], v[36:51]
ds_read_b64_tr_b16 v[86:87], v8 offset:43776
ds_read_b64_tr_b16 v[88:89], v9 offset:43008
v_mfma_f32_32x32x16_bf16 v[52:67], v[108:111], v[112:115], v[52:67]
ds_read_b64_tr_b16 v[90:91], v9 offset:43776
ds_read_b64_tr_b16 v[92:93], v10 offset:43008
v_mfma_f32_32x32x16_bf16 v[68:83], v[100:103], v[16:19], v[68:83]
ds_read_b64_tr_b16 v[94:95], v10 offset:43776
ds_write_b128 v3, v[156:159] offset:2048
s_waitcnt lgkmcnt(8)
v_mfma_f32_32x32x16_bf16 v[20:35], v[116:119], v[128:131], v[20:35]
ds_read_b128 v[112:115], v254 offset:4096
ds_read_b64_tr_b16 v[100:101], v8 offset:46080
v_mfma_f32_32x32x16_bf16 v[36:51], v[120:123], v[128:131], v[36:51]
ds_read_b64_tr_b16 v[102:103], v8 offset:46848
ds_read_b64_tr_b16 v[104:105], v9 offset:46080
v_mfma_f32_32x32x16_bf16 v[52:67], v[124:127], v[128:131], v[52:67]
ds_read_b64_tr_b16 v[106:107], v9 offset:46848
ds_read_b64_tr_b16 v[108:109], v10 offset:46080
v_mfma_f32_32x32x16_bf16 v[68:83], v[116:119], v[16:19], v[68:83]
ds_read_b64_tr_b16 v[110:111], v10 offset:46848
ds_write_b128 v251, v[160:163] offset:3072
s_waitcnt lgkmcnt(8)
v_mfma_f32_32x32x16_bf16 v[20:35], v[84:87], v[96:99], v[20:35]
v_mfma_f32_32x32x16_bf16 v[36:51], v[88:91], v[96:99], v[36:51]
s_waitcnt vmcnt(9)
s_waitcnt lgkmcnt(0)
s_barrier
ds_read_b128 v[128:131], v4 offset:0
ds_read_b64_tr_b16 v[116:117], v8 offset:0
ds_read_b64_tr_b16 v[118:119], v8 offset:768
v_mfma_f32_32x32x16_bf16 v[52:67], v[92:95], v[96:99], v[52:67]
ds_read_b64_tr_b16 v[120:121], v9 offset:0
ds_read_b64_tr_b16 v[122:123], v9 offset:768
ds_read_b64_tr_b16 v[124:125], v10 offset:0
v_mfma_f32_32x32x16_bf16 v[68:83], v[84:87], v[16:19], v[68:83]
ds_read_b64_tr_b16 v[126:127], v10 offset:768
s_waitcnt vmcnt(5)
ds_write_b128 v3, v[164:167] offset:4096
s_waitcnt lgkmcnt(8)
v_mfma_f32_32x32x16_bf16 v[20:35], v[100:103], v[112:115], v[20:35]
ds_read_b128 v[96:99], v252 offset:0
ds_read_b64_tr_b16 v[84:85], v8 offset:3072
v_mfma_f32_32x32x16_bf16 v[36:51], v[104:107], v[112:115], v[36:51]
ds_read_b64_tr_b16 v[86:87], v8 offset:3840
ds_read_b64_tr_b16 v[88:89], v9 offset:3072
v_mfma_f32_32x32x16_bf16 v[52:67], v[108:111], v[112:115], v[52:67]
ds_read_b64_tr_b16 v[90:91], v9 offset:3840
ds_read_b64_tr_b16 v[92:93], v10 offset:3072
v_mfma_f32_32x32x16_bf16 v[68:83], v[100:103], v[16:19], v[68:83]
ds_read_b64_tr_b16 v[94:95], v10 offset:3840
ds_write_b128 v251, v[168:171] offset:5120
s_waitcnt lgkmcnt(8)
v_mfma_f32_32x32x16_bf16 v[20:35], v[116:119], v[128:131], v[20:35]
ds_read_b128 v[112:115], v253 offset:0
ds_read_b64_tr_b16 v[100:101], v8 offset:6144
v_mfma_f32_32x32x16_bf16 v[36:51], v[120:123], v[128:131], v[36:51]
ds_read_b64_tr_b16 v[102:103], v8 offset:6912
ds_read_b64_tr_b16 v[104:105], v9 offset:6144
v_mfma_f32_32x32x16_bf16 v[52:67], v[124:127], v[128:131], v[52:67]
ds_read_b64_tr_b16 v[106:107], v9 offset:6912
ds_read_b64_tr_b16 v[108:109], v10 offset:6144
v_mfma_f32_32x32x16_bf16 v[68:83], v[116:119], v[16:19], v[68:83]
ds_read_b64_tr_b16 v[110:111], v10 offset:6912
ds_write_b128 v3, v[172:175] offset:6144
s_waitcnt lgkmcnt(8)
v_mfma_f32_32x32x16_bf16 v[20:35], v[84:87], v[96:99], v[20:35]
ds_read_b128 v[128:131], v254 offset:0
ds_read_b64_tr_b16 v[116:117], v8 offset:9216
v_mfma_f32_32x32x16_bf16 v[36:51], v[88:91], v[96:99], v[36:51]
ds_read_b64_tr_b16 v[118:119], v8 offset:9984
ds_read_b64_tr_b16 v[120:121], v9 offset:9216
v_mfma_f32_32x32x16_bf16 v[52:67], v[92:95], v[96:99], v[52:67]
ds_read_b64_tr_b16 v[122:123], v9 offset:9984
ds_read_b64_tr_b16 v[124:125], v10 offset:9216
v_mfma_f32_32x32x16_bf16 v[68:83], v[84:87], v[16:19], v[68:83]
ds_read_b64_tr_b16 v[126:127], v10 offset:9984
ds_write_b128 v251, v[176:179] offset:7168
s_waitcnt lgkmcnt(8)
v_mfma_f32_32x32x16_bf16 v[20:35], v[100:103], v[112:115], v[20:35]
v_mfma_f32_32x32x16_bf16 v[36:51], v[104:107], v[112:115], v[36:51]
s_waitcnt vmcnt(2)
s_waitcnt lgkmcnt(0)
s_barrier
ds_read_b128 v[96:99], v4 offset:4096
ds_read_b64_tr_b16 v[84:85], v8 offset:12288
ds_read_b64_tr_b16 v[86:87], v8 offset:13056
v_mfma_f32_32x32x16_bf16 v[52:67], v[108:111], v[112:115], v[52:67]
ds_read_b64_tr_b16 v[88:89], v9 offset:12288
ds_read_b64_tr_b16 v[90:91], v9 offset:13056
ds_read_b64_tr_b16 v[92:93], v10 offset:12288
v_mfma_f32_32x32x16_bf16 v[68:83], v[100:103], v[16:19], v[68:83]
ds_read_b64_tr_b16 v[94:95], v10 offset:13056
v_and_b32 v12, 31, v1
v_lshlrev_b32 v12, 4, v12
s_lshl_b32 s71, s60, 4
s_add_u32 s71, s71, 2621440
buffer_load_dwordx4 v[246:249], v12, s[36:39], s71 offen sc0 sc1
s_waitcnt lgkmcnt(7)
v_mfma_f32_32x32x16_bf16 v[20:35], v[116:119], v[128:131], v[20:35]
ds_read_b128 v[112:115], v252 offset:4096
ds_read_b64_tr_b16 v[100:101], v8 offset:15360
v_mfma_f32_32x32x16_bf16 v[36:51], v[120:123], v[128:131], v[36:51]
ds_read_b64_tr_b16 v[102:103], v8 offset:16128
ds_read_b64_tr_b16 v[104:105], v9 offset:15360
v_mfma_f32_32x32x16_bf16 v[52:67], v[124:127], v[128:131], v[52:67]
ds_read_b64_tr_b16 v[106:107], v9 offset:16128
ds_read_b64_tr_b16 v[108:109], v10 offset:15360
v_mfma_f32_32x32x16_bf16 v[68:83], v[116:119], v[16:19], v[68:83]
ds_read_b64_tr_b16 v[110:111], v10 offset:16128
s_waitcnt lgkmcnt(7)
v_mfma_f32_32x32x16_bf16 v[20:35], v[84:87], v[96:99], v[20:35]
ds_read_b128 v[128:131], v253 offset:4096
ds_read_b64_tr_b16 v[116:117], v8 offset:18432
v_mfma_f32_32x32x16_bf16 v[36:51], v[88:91], v[96:99], v[36:51]
ds_read_b64_tr_b16 v[118:119], v8 offset:19200
ds_read_b64_tr_b16 v[120:121], v9 offset:18432
v_mfma_f32_32x32x16_bf16 v[52:67], v[92:95], v[96:99], v[52:67]
ds_read_b64_tr_b16 v[122:123], v9 offset:19200
ds_read_b64_tr_b16 v[124:125], v10 offset:18432
v_mfma_f32_32x32x16_bf16 v[68:83], v[84:87], v[16:19], v[68:83]
ds_read_b64_tr_b16 v[126:127], v10 offset:19200
s_waitcnt lgkmcnt(7)
v_mfma_f32_32x32x16_bf16 v[20:35], v[100:103], v[112:115], v[20:35]
ds_read_b128 v[96:99], v254 offset:4096
ds_read_b64_tr_b16 v[84:85], v8 offset:21504
v_mfma_f32_32x32x16_bf16 v[36:51], v[104:107], v[112:115], v[36:51]
ds_read_b64_tr_b16 v[86:87], v8 offset:22272
ds_read_b64_tr_b16 v[88:89], v9 offset:21504
v_mfma_f32_32x32x16_bf16 v[52:67], v[108:111], v[112:115], v[52:67]
ds_read_b64_tr_b16 v[90:91], v9 offset:22272
ds_read_b64_tr_b16 v[92:93], v10 offset:21504
v_mfma_f32_32x32x16_bf16 v[68:83], v[100:103], v[16:19], v[68:83]
ds_read_b64_tr_b16 v[94:95], v10 offset:22272
s_waitcnt lgkmcnt(7)
v_mfma_f32_32x32x16_bf16 v[20:35], v[116:119], v[128:131], v[20:35]
v_mfma_f32_32x32x16_bf16 v[36:51], v[120:123], v[128:131], v[36:51]
v_mfma_f32_32x32x16_bf16 v[52:67], v[124:127], v[128:131], v[52:67]
v_mfma_f32_32x32x16_bf16 v[68:83], v[116:119], v[16:19], v[68:83]
s_waitcnt lgkmcnt(0)
v_mfma_f32_32x32x16_bf16 v[20:35], v[84:87], v[96:99], v[20:35]
v_mfma_f32_32x32x16_bf16 v[36:51], v[88:91], v[96:99], v[36:51]
v_mfma_f32_32x32x16_bf16 v[52:67], v[92:95], v[96:99], v[52:67]
v_mfma_f32_32x32x16_bf16 v[68:83], v[84:87], v[16:19], v[68:83]
s_waitcnt vmcnt(0)
v_lshrrev_b32 v11, 5, v1
v_lshlrev_b32 v11, 4, v11
s_lshl_b32 s70, s67, 7
s_add_u32 s70, s70, 65536
v_add_u32 v13, s70, v11
v_lshlrev_b32 v84, 16, v250
v_and_b32 v85, 0xffff0000, v250
v_lshlrev_b32 v14, 3, v1
v_add_u32 v14, 66048, v14
v_readfirstlane_b32 s76, v244
s_mov_b32 exec_lo, 1
s_mov_b32 exec_hi, 1
ds_write_b128 v13, v[68:71] offset:0
ds_write_b128 v13, v[72:75] offset:32
ds_write_b128 v13, v[76:79] offset:64
ds_write_b128 v13, v[80:83] offset:96
s_mov_b32 exec_lo, -1
s_mov_b32 exec_hi, 0xffff
ds_write_b64 v14, v[84:85]
s_mov_b64 exec, -1
s_cmp_lg_u32 s76, 0
s_cbranch_scc1 L_gek_23
s_mov_b32 s98, 200000
L_ep_26:
buffer_load_dword v244, v15, s[48:51], 0 offen sc0 sc1
s_waitcnt vmcnt(0)
v_readfirstlane_b32 s76, v244
s_cmp_lg_u32 s76, 0
s_cbranch_scc1 L_epd_27
s_sleep 2
s_sub_u32 s98, s98, 1
s_cmp_lg_u32 s98, 0
s_cbranch_scc1 L_ep_26
L_epd_27:
L_gek_23:
s_mov_b32 s98, 200000
L_gp_24:
v_xor_b32 v13, s76, v247
v_xor_b32 v14, s76, v249
v_or_b32 v13, v13, v14
v_cmp_ne_u32 vcc, 0, v13
s_nop 1
s_cmp_eq_u64 vcc, 0
s_cbranch_scc1 L_gpd_25
s_sub_u32 s98, s98, 1
s_cmp_eq_u32 s98, 0
s_cbranch_scc1 L_gpd_25
s_sleep 2
buffer_load_dwordx4 v[246:249], v12, s[36:39], s71 offen sc0 sc1
s_waitcnt vmcnt(0)
s_branch L_gp_24
L_gpd_25:
s_waitcnt lgkmcnt(0)
s_barrier
v_min_u32 v12, 11, v1
v_lshlrev_b32 v12, 7, v12
s_and_b32 s73, s55, 7
s_mul_i32 s73, s73, 48
s_mul_i32 s72, s52, 12
s_add_u32 s73, s73, s72
s_lshl_b32 s73, s73, 7
s_add_u32 s73, s73, 13893632
buffer_load_dword v252, v12, s[36:39], s73 offen sc0 sc1
s_lshl_b32 s70, s67, 7
s_add_u32 s70, s70, 65536
v_add_u32 v13, s70, v11
ds_read_b128 v[132:135], v13 offset:0
ds_read_b128 v[180:183], v13 offset:512
ds_read_b128 v[136:139], v13 offset:32
ds_read_b128 v[184:187], v13 offset:544
ds_read_b128 v[140:143], v13 offset:64
ds_read_b128 v[188:191], v13 offset:576
ds_read_b128 v[144:147], v13 offset:96
ds_read_b128 v[192:195], v13 offset:608
s_lshl_b32 s70, s68, 7
s_add_u32 s70, s70, 65536
v_add_u32 v13, s70, v11
ds_read_b128 v[148:151], v13 offset:0
ds_read_b128 v[196:199], v13 offset:512
ds_read_b128 v[152:155], v13 offset:32
ds_read_b128 v[200:203], v13 offset:544
ds_read_b128 v[156:159], v13 offset:64
ds_read_b128 v[204:207], v13 offset:576
ds_read_b128 v[160:163], v13 offset:96
ds_read_b128 v[208:211], v13 offset:608
s_lshl_b32 s70, s69, 7
s_add_u32 s70, s70, 65536
v_add_u32 v13, s70, v11
ds_read_b128 v[164:167], v13 offset:0
ds_read_b128 v[212:215], v13 offset:512
ds_read_b128 v[168:171], v13 offset:32
ds_read_b128 v[216:219], v13 offset:544
ds_read_b128 v[172:175], v13 offset:64
ds_read_b128 v[220:223], v13 offset:576
ds_read_b128 v[176:179], v13 offset:96
ds_read_b128 v[224:227], v13 offset:608
s_lshl_b32 s70, s56, 1
s_lshr_b32 s71, s52, 1
s_add_u32 s70, s70, s71
s_mul_i32 s70, s70, 48
s_mul_i32 s71, s57, 3
s_add_u32 s70, s70, s71
s_and_b32 s71, s52, 1
s_lshl_b32 s71, s71, 11
s_add_u32 s71, s71, 7471104
v_and_b32 v13, 15, v1
v_lshlrev_b32 v13, 4, v13
v_lshlrev_b32 v14, 4, v11
v_add_u32 v13, v13, v14
v_bfe_u32 v14, v1, 4, 1
v_lshlrev_b32 v14, 10, v14
v_add_u32 v13, v13, v14
s_mov_b32 s74, 0x3fb8aa3b
s_mov_b32 s75, 0x3fb8aa3b
s_mov_b32 s78, 0x41e00000
s_add_u32 s72, s70, s67
s_lshl_b32 s72, s72, 12
s_add_u32 s72, s72, s71
s_waitcnt lgkmcnt(15)
v_pk_fma_f32 v[84:85], v[132:133], v[248:249], v[180:181] op_sel:[0,0,0] op_sel_hi:[1,0,1]
v_pk_fma_f32 v[90:91], v[134:135], v[248:249], v[182:183] op_sel:[0,0,0] op_sel_hi:[1,0,1]
v_pk_fma_f32 v[96:97], v[136:137], v[248:249], v[184:185] op_sel:[0,0,0] op_sel_hi:[1,0,1]
v_pk_fma_f32 v[102:103], v[138:139], v[248:249], v[186:187] op_sel:[0,0,0] op_sel_hi:[1,0,1]
v_pk_fma_f32 v[108:109], v[140:141], v[248:249], v[188:189] op_sel:[0,0,0] op_sel_hi:[1,0,1]
v_pk_fma_f32 v[114:115], v[142:143], v[248:249], v[190:191] op_sel:[0,0,0] op_sel_hi:[1,0,1]
v_pk_fma_f32 v[120:121], v[144:145], v[248:249], v[192:193] op_sel:[0,0,0] op_sel_hi:[1,0,1]
v_pk_fma_f32 v[126:127], v[146:147], v[248:249], v[194:195] op_sel:[0,0,0] op_sel_hi:[1,0,1]
v_pk_fma_f32 v[84:85], v[20:21], v[246:247], v[84:85] op_sel:[0,0,0] op_sel_hi:[1,0,1]
v_pk_fma_f32 v[90:91], v[22:23], v[246:247], v[90:91] op_sel:[0,0,0] op_sel_hi:[1,0,1]
v_pk_fma_f32 v[96:97], v[24:25], v[246:247], v[96:97] op_sel:[0,0,0] op_sel_hi:[1,0,1]
v_pk_fma_f32 v[102:103], v[26:27], v[246:247], v[102:103] op_sel:[0,0,0] op_sel_hi:[1,0,1]
v_pk_fma_f32 v[108:109], v[28:29], v[246:247], v[108:109] op_sel:[0,0,0] op_sel_hi:[1,0,1]
v_pk_fma_f32 v[114:115], v[30:31], v[246:247], v[114:115] op_sel:[0,0,0] op_sel_hi:[1,0,1]
v_pk_fma_f32 v[120:121], v[32:33], v[246:247], v[120:121] op_sel:[0,0,0] op_sel_hi:[1,0,1]
v_pk_fma_f32 v[126:127], v[34:35], v[246:247], v[126:127] op_sel:[0,0,0] op_sel_hi:[1,0,1]
v_pk_mul_f32 v[86:87], v[84:85], s[74:75]
v_pk_mul_f32 v[92:93], v[90:91], s[74:75]
v_pk_mul_f32 v[98:99], v[96:97], s[74:75]
v_pk_mul_f32 v[104:105], v[102:103], s[74:75]
v_pk_mul_f32 v[110:111], v[108:109], s[74:75]
v_pk_mul_f32 v[116:117], v[114:115], s[74:75]
v_pk_mul_f32 v[122:123], v[120:121], s[74:75]
v_pk_mul_f32 v[128:129], v[126:127], s[74:75]
v_min_f32 v86, s78, v86
v_min_f32 v87, s78, v87
v_min_f32 v92, s78, v92
v_min_f32 v93, s78, v93
v_min_f32 v98, s78, v98
v_min_f32 v99, s78, v99
v_min_f32 v104, s78, v104
v_min_f32 v105, s78, v105
v_min_f32 v110, s78, v110
v_min_f32 v111, s78, v111
v_min_f32 v116, s78, v116
v_min_f32 v117, s78, v117
v_min_f32 v122, s78, v122
v_min_f32 v123, s78, v123
v_min_f32 v128, s78, v128
v_min_f32 v129, s78, v129
v_exp_f32 v86, v86
v_exp_f32 v87, v87
v_exp_f32 v92, v92
v_exp_f32 v93, v93
v_exp_f32 v98, v98
v_exp_f32 v99, v99
v_exp_f32 v104, v104
v_exp_f32 v105, v105
v_exp_f32 v110, v110
v_exp_f32 v111, v111
v_exp_f32 v116, v116
v_exp_f32 v117, v117
v_exp_f32 v122, v122
v_exp_f32 v123, v123
v_exp_f32 v128, v128
v_exp_f32 v129, v129
v_pk_add_f32 v[88:89], v[86:87], 2.0 op_sel_hi:[1,0]
v_pk_add_f32 v[94:95], v[92:93], 2.0 op_sel_hi:[1,0]
v_pk_add_f32 v[100:101], v[98:99], 2.0 op_sel_hi:[1,0]
v_pk_add_f32 v[106:107], v[104:105], 2.0 op_sel_hi:[1,0]
v_pk_add_f32 v[112:113], v[110:111], 2.0 op_sel_hi:[1,0]
v_pk_add_f32 v[118:119], v[116:117], 2.0 op_sel_hi:[1,0]
v_pk_add_f32 v[124:125], v[122:123], 2.0 op_sel_hi:[1,0]
v_pk_add_f32 v[130:131], v[128:129], 2.0 op_sel_hi:[1,0]
v_pk_fma_f32 v[88:89], v[86:87], v[88:89], 2.0 op_sel_hi:[1,1,0]
v_pk_fma_f32 v[94:95], v[92:93], v[94:95], 2.0 op_sel_hi:[1,1,0]
v_pk_fma_f32 v[100:101], v[98:99], v[100:101], 2.0 op_sel_hi:[1,1,0]
v_pk_fma_f32 v[106:107], v[104:105], v[106:107], 2.0 op_sel_hi:[1,1,0]
v_pk_fma_f32 v[112:113], v[110:111], v[112:113], 2.0 op_sel_hi:[1,1,0]
v_pk_fma_f32 v[118:119], v[116:117], v[118:119], 2.0 op_sel_hi:[1,1,0]
v_pk_fma_f32 v[124:125], v[122:123], v[124:125], 2.0 op_sel_hi:[1,1,0]
v_pk_fma_f32 v[130:131], v[128:129], v[130:131], 2.0 op_sel_hi:[1,1,0]
v_rcp_f32 v88, v88
v_rcp_f32 v89, v89
v_rcp_f32 v94, v94
v_rcp_f32 v95, v95
v_rcp_f32 v100, v100
v_rcp_f32 v101, v101
v_rcp_f32 v106, v106
v_rcp_f32 v107, v107
v_rcp_f32 v112, v112
v_rcp_f32 v113, v113
v_rcp_f32 v118, v118
v_rcp_f32 v119, v119
v_rcp_f32 v124, v124
v_rcp_f32 v125, v125
v_rcp_f32 v130, v130
v_rcp_f32 v131, v131
v_pk_mul_f32 v[88:89], v[88:89], v[84:85]
v_pk_mul_f32 v[94:95], v[94:95], v[90:91]
v_pk_mul_f32 v[100:101], v[100:101], v[96:97]
v_pk_mul_f32 v[106:107], v[106:107], v[102:103]
v_pk_mul_f32 v[112:113], v[112:113], v[108:109]
v_pk_mul_f32 v[118:119], v[118:119], v[114:115]
v_pk_mul_f32 v[124:125], v[124:125], v[120:121]
v_pk_mul_f32 v[130:131], v[130:131], v[126:127]
v_pk_fma_f32 v[84:85], v[88:89], -2.0, v[84:85] op_sel_hi:[1,0,1]
v_pk_fma_f32 v[90:91], v[94:95], -2.0, v[90:91] op_sel_hi:[1,0,1]
v_pk_fma_f32 v[96:97], v[100:101], -2.0, v[96:97] op_sel_hi:[1,0,1]
v_pk_fma_f32 v[102:103], v[106:107], -2.0, v[102:103] op_sel_hi:[1,0,1]
v_pk_fma_f32 v[108:109], v[112:113], -2.0, v[108:109] op_sel_hi:[1,0,1]
v_pk_fma_f32 v[114:115], v[118:119], -2.0, v[114:115] op_sel_hi:[1,0,1]
v_pk_fma_f32 v[120:121], v[124:125], -2.0, v[120:121] op_sel_hi:[1,0,1]
v_pk_fma_f32 v[126:127], v[130:131], -2.0, v[126:127] op_sel_hi:[1,0,1]
v_cvt_pk_bf16_f32 v228, v84, v85
v_cvt_pk_bf16_f32 v229, v90, v91
v_cvt_pk_bf16_f32 v230, v96, v97
v_cvt_pk_bf16_f32 v231, v102, v103
v_cvt_pk_bf16_f32 v232, v108, v109
v_cvt_pk_bf16_f32 v233, v114, v115
v_cvt_pk_bf16_f32 v234, v120, v121
v_cvt_pk_bf16_f32 v235, v126, v127
buffer_store_dwordx4 v[228:231], v13, s[36:39], s72 offen sc0 sc1
buffer_store_dwordx4 v[232:235], v13, s[36:39], s72 offen offset:512 sc0 sc1
s_add_u32 s72, s70, s68
s_lshl_b32 s72, s72, 12
s_add_u32 s72, s72, s71
s_waitcnt lgkmcnt(8)
v_pk_fma_f32 v[84:85], v[148:149], v[248:249], v[196:197] op_sel:[0,0,0] op_sel_hi:[1,0,1]
v_pk_fma_f32 v[90:91], v[150:151], v[248:249], v[198:199] op_sel:[0,0,0] op_sel_hi:[1,0,1]
v_pk_fma_f32 v[96:97], v[152:153], v[248:249], v[200:201] op_sel:[0,0,0] op_sel_hi:[1,0,1]
v_pk_fma_f32 v[102:103], v[154:155], v[248:249], v[202:203] op_sel:[0,0,0] op_sel_hi:[1,0,1]
v_pk_fma_f32 v[108:109], v[156:157], v[248:249], v[204:205] op_sel:[0,0,0] op_sel_hi:[1,0,1]
v_pk_fma_f32 v[114:115], v[158:159], v[248:249], v[206:207] op_sel:[0,0,0] op_sel_hi:[1,0,1]
v_pk_fma_f32 v[120:121], v[160:161], v[248:249], v[208:209] op_sel:[0,0,0] op_sel_hi:[1,0,1]
v_pk_fma_f32 v[126:127], v[162:163], v[248:249], v[210:211] op_sel:[0,0,0] op_sel_hi:[1,0,1]
v_pk_fma_f32 v[84:85], v[36:37], v[246:247], v[84:85] op_sel:[0,0,0] op_sel_hi:[1,0,1]
v_pk_fma_f32 v[90:91], v[38:39], v[246:247], v[90:91] op_sel:[0,0,0] op_sel_hi:[1,0,1]
v_pk_fma_f32 v[96:97], v[40:41], v[246:247], v[96:97] op_sel:[0,0,0] op_sel_hi:[1,0,1]
v_pk_fma_f32 v[102:103], v[42:43], v[246:247], v[102:103] op_sel:[0,0,0] op_sel_hi:[1,0,1]
v_pk_fma_f32 v[108:109], v[44:45], v[246:247], v[108:109] op_sel:[0,0,0] op_sel_hi:[1,0,1]
v_pk_fma_f32 v[114:115], v[46:47], v[246:247], v[114:115] op_sel:[0,0,0] op_sel_hi:[1,0,1]
v_pk_fma_f32 v[120:121], v[48:49], v[246:247], v[120:121] op_sel:[0,0,0] op_sel_hi:[1,0,1]
v_pk_fma_f32 v[126:127], v[50:51], v[246:247], v[126:127] op_sel:[0,0,0] op_sel_hi:[1,0,1]
v_pk_mul_f32 v[86:87], v[84:85], s[74:75]
v_pk_mul_f32 v[92:93], v[90:91], s[74:75]
v_pk_mul_f32 v[98:99], v[96:97], s[74:75]
v_pk_mul_f32 v[104:105], v[102:103], s[74:75]
v_pk_mul_f32 v[110:111], v[108:109], s[74:75]
v_pk_mul_f32 v[116:117], v[114:115], s[74:75]
v_pk_mul_f32 v[122:123], v[120:121], s[74:75]
v_pk_mul_f32 v[128:129], v[126:127], s[74:75]
v_min_f32 v86, s78, v86
v_min_f32 v87, s78, v87
v_min_f32 v92, s78, v92
v_min_f32 v93, s78, v93
v_min_f32 v98, s78, v98
v_min_f32 v99, s78, v99
v_min_f32 v104, s78, v104
v_min_f32 v105, s78, v105
v_min_f32 v110, s78, v110
v_min_f32 v111, s78, v111
v_min_f32 v116, s78, v116
v_min_f32 v117, s78, v117
v_min_f32 v122, s78, v122
v_min_f32 v123, s78, v123
v_min_f32 v128, s78, v128
v_min_f32 v129, s78, v129
v_exp_f32 v86, v86
v_exp_f32 v87, v87
v_exp_f32 v92, v92
v_exp_f32 v93, v93
v_exp_f32 v98, v98
v_exp_f32 v99, v99
v_exp_f32 v104, v104
v_exp_f32 v105, v105
v_exp_f32 v110, v110
v_exp_f32 v111, v111
v_exp_f32 v116, v116
v_exp_f32 v117, v117
v_exp_f32 v122, v122
v_exp_f32 v123, v123
v_exp_f32 v128, v128
v_exp_f32 v129, v129
v_pk_add_f32 v[88:89], v[86:87], 2.0 op_sel_hi:[1,0]
v_pk_add_f32 v[94:95], v[92:93], 2.0 op_sel_hi:[1,0]
v_pk_add_f32 v[100:101], v[98:99], 2.0 op_sel_hi:[1,0]
v_pk_add_f32 v[106:107], v[104:105], 2.0 op_sel_hi:[1,0]
v_pk_add_f32 v[112:113], v[110:111], 2.0 op_sel_hi:[1,0]
v_pk_add_f32 v[118:119], v[116:117], 2.0 op_sel_hi:[1,0]
v_pk_add_f32 v[124:125], v[122:123], 2.0 op_sel_hi:[1,0]
v_pk_add_f32 v[130:131], v[128:129], 2.0 op_sel_hi:[1,0]
v_pk_fma_f32 v[88:89], v[86:87], v[88:89], 2.0 op_sel_hi:[1,1,0]
v_pk_fma_f32 v[94:95], v[92:93], v[94:95], 2.0 op_sel_hi:[1,1,0]
v_pk_fma_f32 v[100:101], v[98:99], v[100:101], 2.0 op_sel_hi:[1,1,0]
v_pk_fma_f32 v[106:107], v[104:105], v[106:107], 2.0 op_sel_hi:[1,1,0]
v_pk_fma_f32 v[112:113], v[110:111], v[112:113], 2.0 op_sel_hi:[1,1,0]
v_pk_fma_f32 v[118:119], v[116:117], v[118:119], 2.0 op_sel_hi:[1,1,0]
v_pk_fma_f32 v[124:125], v[122:123], v[124:125], 2.0 op_sel_hi:[1,1,0]
v_pk_fma_f32 v[130:131], v[128:129], v[130:131], 2.0 op_sel_hi:[1,1,0]
v_rcp_f32 v88, v88
v_rcp_f32 v89, v89
v_rcp_f32 v94, v94
v_rcp_f32 v95, v95
v_rcp_f32 v100, v100
v_rcp_f32 v101, v101
v_rcp_f32 v106, v106
v_rcp_f32 v107, v107
v_rcp_f32 v112, v112
v_rcp_f32 v113, v113
v_rcp_f32 v118, v118
v_rcp_f32 v119, v119
v_rcp_f32 v124, v124
v_rcp_f32 v125, v125
v_rcp_f32 v130, v130
v_rcp_f32 v131, v131
v_pk_mul_f32 v[88:89], v[88:89], v[84:85]
v_pk_mul_f32 v[94:95], v[94:95], v[90:91]
v_pk_mul_f32 v[100:101], v[100:101], v[96:97]
v_pk_mul_f32 v[106:107], v[106:107], v[102:103]
v_pk_mul_f32 v[112:113], v[112:113], v[108:109]
v_pk_mul_f32 v[118:119], v[118:119], v[114:115]
v_pk_mul_f32 v[124:125], v[124:125], v[120:121]
v_pk_mul_f32 v[130:131], v[130:131], v[126:127]
v_pk_fma_f32 v[84:85], v[88:89], -2.0, v[84:85] op_sel_hi:[1,0,1]
v_pk_fma_f32 v[90:91], v[94:95], -2.0, v[90:91] op_sel_hi:[1,0,1]
v_pk_fma_f32 v[96:97], v[100:101], -2.0, v[96:97] op_sel_hi:[1,0,1]
v_pk_fma_f32 v[102:103], v[106:107], -2.0, v[102:103] op_sel_hi:[1,0,1]
v_pk_fma_f32 v[108:109], v[112:113], -2.0, v[108:109] op_sel_hi:[1,0,1]
v_pk_fma_f32 v[114:115], v[118:119], -2.0, v[114:115] op_sel_hi:[1,0,1]
v_pk_fma_f32 v[120:121], v[124:125], -2.0, v[120:121] op_sel_hi:[1,0,1]
v_pk_fma_f32 v[126:127], v[130:131], -2.0, v[126:127] op_sel_hi:[1,0,1]
v_cvt_pk_bf16_f32 v236, v84, v85
v_cvt_pk_bf16_f32 v237, v90, v91
v_cvt_pk_bf16_f32 v238, v96, v97
v_cvt_pk_bf16_f32 v239, v102, v103
v_cvt_pk_bf16_f32 v240, v108, v109
v_cvt_pk_bf16_f32 v241, v114, v115
v_cvt_pk_bf16_f32 v242, v120, v121
v_cvt_pk_bf16_f32 v243, v126, v127
buffer_store_dwordx4 v[236:239], v13, s[36:39], s72 offen sc0 sc1
buffer_store_dwordx4 v[240:243], v13, s[36:39], s72 offen offset:512 sc0 sc1
s_add_u32 s72, s70, s69
s_lshl_b32 s72, s72, 12
s_add_u32 s72, s72, s71
s_waitcnt lgkmcnt(0)
s_lshl_b32 s73, s56, 4
s_add_u32 s73, s73, s57
s_lshl_b32 s73, s73, 7
s_add_u32 s73, s73, 13959232
v_mov_b32 v244, s76
s_cmp_lg_u32 s52, 0
s_cbranch_scc1 L_hint_28
s_mov_b64 exec, 1
buffer_store_dword v244, v15, s[36:39], s73 offen sc0 sc1
s_mov_b64 exec, -1
L_hint_28:
v_pk_fma_f32 v[84:85], v[164:165], v[248:249], v[212:213] op_sel:[0,0,0] op_sel_hi:[1,0,1]
v_pk_fma_f32 v[90:91], v[166:167], v[248:249], v[214:215] op_sel:[0,0,0] op_sel_hi:[1,0,1]
v_pk_fma_f32 v[96:97], v[168:169], v[248:249], v[216:217] op_sel:[0,0,0] op_sel_hi:[1,0,1]
v_pk_fma_f32 v[102:103], v[170:171], v[248:249], v[218:219] op_sel:[0,0,0] op_sel_hi:[1,0,1]
v_pk_fma_f32 v[108:109], v[172:173], v[248:249], v[220:221] op_sel:[0,0,0] op_sel_hi:[1,0,1]
v_pk_fma_f32 v[114:115], v[174:175], v[248:249], v[222:223] op_sel:[0,0,0] op_sel_hi:[1,0,1]
v_pk_fma_f32 v[120:121], v[176:177], v[248:249], v[224:225] op_sel:[0,0,0] op_sel_hi:[1,0,1]
v_pk_fma_f32 v[126:127], v[178:179], v[248:249], v[226:227] op_sel:[0,0,0] op_sel_hi:[1,0,1]
v_pk_fma_f32 v[84:85], v[52:53], v[246:247], v[84:85] op_sel:[0,0,0] op_sel_hi:[1,0,1]
v_pk_fma_f32 v[90:91], v[54:55], v[246:247], v[90:91] op_sel:[0,0,0] op_sel_hi:[1,0,1]
v_pk_fma_f32 v[96:97], v[56:57], v[246:247], v[96:97] op_sel:[0,0,0] op_sel_hi:[1,0,1]
v_pk_fma_f32 v[102:103], v[58:59], v[246:247], v[102:103] op_sel:[0,0,0] op_sel_hi:[1,0,1]
v_pk_fma_f32 v[108:109], v[60:61], v[246:247], v[108:109] op_sel:[0,0,0] op_sel_hi:[1,0,1]
v_pk_fma_f32 v[114:115], v[62:63], v[246:247], v[114:115] op_sel:[0,0,0] op_sel_hi:[1,0,1]
v_pk_fma_f32 v[120:121], v[64:65], v[246:247], v[120:121] op_sel:[0,0,0] op_sel_hi:[1,0,1]
v_pk_fma_f32 v[126:127], v[66:67], v[246:247], v[126:127] op_sel:[0,0,0] op_sel_hi:[1,0,1]
v_pk_mul_f32 v[86:87], v[84:85], s[74:75]
v_pk_mul_f32 v[92:93], v[90:91], s[74:75]
v_pk_mul_f32 v[98:99], v[96:97], s[74:75]
v_pk_mul_f32 v[104:105], v[102:103], s[74:75]
v_pk_mul_f32 v[110:111], v[108:109], s[74:75]
v_pk_mul_f32 v[116:117], v[114:115], s[74:75]
v_pk_mul_f32 v[122:123], v[120:121], s[74:75]
v_pk_mul_f32 v[128:129], v[126:127], s[74:75]
v_min_f32 v86, s78, v86
v_min_f32 v87, s78, v87
v_min_f32 v92, s78, v92
v_min_f32 v93, s78, v93
v_min_f32 v98, s78, v98
v_min_f32 v99, s78, v99
v_min_f32 v104, s78, v104
v_min_f32 v105, s78, v105
v_min_f32 v110, s78, v110
v_min_f32 v111, s78, v111
v_min_f32 v116, s78, v116
v_min_f32 v117, s78, v117
v_min_f32 v122, s78, v122
v_min_f32 v123, s78, v123
v_min_f32 v128, s78, v128
v_min_f32 v129, s78, v129
v_exp_f32 v86, v86
v_exp_f32 v87, v87
v_exp_f32 v92, v92
v_exp_f32 v93, v93
v_exp_f32 v98, v98
v_exp_f32 v99, v99
v_exp_f32 v104, v104
v_exp_f32 v105, v105
v_exp_f32 v110, v110
v_exp_f32 v111, v111
v_exp_f32 v116, v116
v_exp_f32 v117, v117
v_exp_f32 v122, v122
v_exp_f32 v123, v123
v_exp_f32 v128, v128
v_exp_f32 v129, v129
v_pk_add_f32 v[88:89], v[86:87], 2.0 op_sel_hi:[1,0]
v_pk_add_f32 v[94:95], v[92:93], 2.0 op_sel_hi:[1,0]
v_pk_add_f32 v[100:101], v[98:99], 2.0 op_sel_hi:[1,0]
v_pk_add_f32 v[106:107], v[104:105], 2.0 op_sel_hi:[1,0]
v_pk_add_f32 v[112:113], v[110:111], 2.0 op_sel_hi:[1,0]
v_pk_add_f32 v[118:119], v[116:117], 2.0 op_sel_hi:[1,0]
v_pk_add_f32 v[124:125], v[122:123], 2.0 op_sel_hi:[1,0]
v_pk_add_f32 v[130:131], v[128:129], 2.0 op_sel_hi:[1,0]
v_pk_fma_f32 v[88:89], v[86:87], v[88:89], 2.0 op_sel_hi:[1,1,0]
v_pk_fma_f32 v[94:95], v[92:93], v[94:95], 2.0 op_sel_hi:[1,1,0]
v_pk_fma_f32 v[100:101], v[98:99], v[100:101], 2.0 op_sel_hi:[1,1,0]
v_pk_fma_f32 v[106:107], v[104:105], v[106:107], 2.0 op_sel_hi:[1,1,0]
v_pk_fma_f32 v[112:113], v[110:111], v[112:113], 2.0 op_sel_hi:[1,1,0]
v_pk_fma_f32 v[118:119], v[116:117], v[118:119], 2.0 op_sel_hi:[1,1,0]
v_pk_fma_f32 v[124:125], v[122:123], v[124:125], 2.0 op_sel_hi:[1,1,0]
v_pk_fma_f32 v[130:131], v[128:129], v[130:131], 2.0 op_sel_hi:[1,1,0]
v_rcp_f32 v88, v88
v_rcp_f32 v89, v89
v_rcp_f32 v94, v94
v_rcp_f32 v95, v95
v_rcp_f32 v100, v100
v_rcp_f32 v101, v101
v_rcp_f32 v106, v106
v_rcp_f32 v107, v107
v_rcp_f32 v112, v112
v_rcp_f32 v113, v113
v_rcp_f32 v118, v118
v_rcp_f32 v119, v119
v_rcp_f32 v124, v124
v_rcp_f32 v125, v125
v_rcp_f32 v130, v130
v_rcp_f32 v131, v131
v_pk_mul_f32 v[88:89], v[88:89], v[84:85]
v_pk_mul_f32 v[94:95], v[94:95], v[90:91]
v_pk_mul_f32 v[100:101], v[100:101], v[96:97]
v_pk_mul_f32 v[106:107], v[106:107], v[102:103]
v_pk_mul_f32 v[112:113], v[112:113], v[108:109]
v_pk_mul_f32 v[118:119], v[118:119], v[114:115]
v_pk_mul_f32 v[124:125], v[124:125], v[120:121]
v_pk_mul_f32 v[130:131], v[130:131], v[126:127]
v_pk_fma_f32 v[84:85], v[88:89], -2.0, v[84:85] op_sel_hi:[1,0,1]
v_pk_fma_f32 v[90:91], v[94:95], -2.0, v[90:91] op_sel_hi:[1,0,1]
v_pk_fma_f32 v[96:97], v[100:101], -2.0, v[96:97] op_sel_hi:[1,0,1]
v_pk_fma_f32 v[102:103], v[106:107], -2.0, v[102:103] op_sel_hi:[1,0,1]
v_pk_fma_f32 v[108:109], v[112:113], -2.0, v[108:109] op_sel_hi:[1,0,1]
v_pk_fma_f32 v[114:115], v[118:119], -2.0, v[114:115] op_sel_hi:[1,0,1]
v_pk_fma_f32 v[120:121], v[124:125], -2.0, v[120:121] op_sel_hi:[1,0,1]
v_pk_fma_f32 v[126:127], v[130:131], -2.0, v[126:127] op_sel_hi:[1,0,1]
v_cvt_pk_bf16_f32 v228, v84, v85
v_cvt_pk_bf16_f32 v229, v90, v91
v_cvt_pk_bf16_f32 v230, v96, v97
v_cvt_pk_bf16_f32 v231, v102, v103
v_cvt_pk_bf16_f32 v232, v108, v109
v_cvt_pk_bf16_f32 v233, v114, v115
v_cvt_pk_bf16_f32 v234, v120, v121
v_cvt_pk_bf16_f32 v235, v126, v127
buffer_store_dwordx4 v[228:231], v13, s[36:39], s72 offen sc0 sc1
buffer_store_dwordx4 v[232:235], v13, s[36:39], s72 offen offset:512 sc0 sc1
s_setprio 1
s_lshl_b32 s79, s56, 4
s_add_u32 s79, s79, s57
s_lshl_b32 s79, s79, 7
s_lshl_b32 s71, s52, 2
s_add_u32 s79, s79, s71
s_add_u32 s79, s79, 13959168
s_mov_b32 s44, s30
s_and_b32 s45, s31, 0xffff
s_mov_b32 s46, 2621440
s_mov_b32 s47, 0x00020000
s_lshl_b32 s56, s54, 2
s_lshr_b32 s57, s55, 3
s_add_u32 s56, s56, s57
s_and_b32 s57, s55, 7
v_lshlrev_b32 v6, 4, v1
v_add_u32 v7, 4096, v6
s_mul_i32 s58, s52, 12
s_mul_i32 s59, s56, 48
s_add_u32 s59, s59, s58
s_lshl_b32 s59, s59, 12
s_add_u32 s59, s59, 7471104
s_mul_i32 s60, s57, 48
s_add_u32 s60, s60, s58
s_mul_i32 s60, s60, 5120
s_add_u32 s60, s60, 5505024
s_add_u32 s61, s52, 0
s_and_b32 s61, s61, 3
s_lshl_b32 s66, s61, 10
v_add_u32 v16, s66, v6
s_add_u32 s61, s52, 1
s_and_b32 s61, s61, 3
s_lshl_b32 s67, s61, 10
v_add_u32 v17, s67, v6
s_add_u32 s61, s52, 2
s_and_b32 s61, s61, 3
s_lshl_b32 s68, s61, 10
v_add_u32 v18, s68, v6
s_add_u32 s61, s52, 3
s_and_b32 s61, s61, 3
s_lshl_b32 s69, s61, 10
v_add_u32 v19, s69, v6
v_mov_b32 v28, 0
v_mov_b32 v29, 0
v_mov_b32 v30, 0
v_mov_b32 v31, 0
v_mov_b32 v32, 0
v_mov_b32 v33, 0
v_mov_b32 v34, 0
v_mov_b32 v35, 0
v_mov_b32 v36, 0
v_mov_b32 v37, 0
v_mov_b32 v38, 0
v_mov_b32 v39, 0
v_mov_b32 v40, 0
v_mov_b32 v41, 0
v_mov_b32 v42, 0
v_mov_b32 v43, 0
v_mov_b32 v44, 0
v_mov_b32 v45, 0
v_mov_b32 v46, 0
v_mov_b32 v47, 0
v_mov_b32 v48, 0
v_mov_b32 v49, 0
v_mov_b32 v50, 0
v_mov_b32 v51, 0
v_mov_b32 v52, 0
v_mov_b32 v53, 0
v_mov_b32 v54, 0
v_mov_b32 v55, 0
v_mov_b32 v56, 0
v_mov_b32 v57, 0
v_mov_b32 v58, 0
v_mov_b32 v59, 0
v_mov_b32 v60, 0
v_mov_b32 v61, 0
v_mov_b32 v62, 0
v_mov_b32 v63, 0
v_mov_b32 v64, 0
v_mov_b32 v65, 0
v_mov_b32 v66, 0
v_mov_b32 v67, 0
v_mov_b32 v68, 0
v_mov_b32 v69, 0
v_mov_b32 v70, 0
v_mov_b32 v71, 0
v_mov_b32 v72, 0
v_mov_b32 v73, 0
v_mov_b32 v74, 0
v_mov_b32 v75, 0
v_mov_b32 v76, 0
v_mov_b32 v77, 0
v_mov_b32 v78, 0
v_mov_b32 v79, 0
v_mov_b32 v80, 0
v_mov_b32 v81, 0
v_mov_b32 v82, 0
v_mov_b32 v83, 0
v_mov_b32 v84, 0
v_mov_b32 v85, 0
v_mov_b32 v86, 0
v_mov_b32 v87, 0
v_mov_b32 v88, 0
v_mov_b32 v89, 0
v_mov_b32 v90, 0
v_mov_b32 v91, 0
v_mov_b32 v92, 0
v_mov_b32 v93, 0
v_mov_b32 v94, 0
v_mov_b32 v95, 0
v_mov_b32 v96, 0
v_mov_b32 v97, 0
v_mov_b32 v98, 0
v_mov_b32 v99, 0
v_mov_b32 v100, 0
v_mov_b32 v101, 0
v_mov_b32 v102, 0
v_mov_b32 v103, 0
v_mov_b32 v104, 0
v_mov_b32 v105, 0
v_mov_b32 v106, 0
v_mov_b32 v107, 0
v_and_b32 v2, 15, v1
v_lshrrev_b32 v3, 4, v1
v_lshrrev_b32 v4, 2, v2
v_mul_u32_u24 v4, 20, v4
v_and_b32 v5, 3, v2
v_add_u32 v4, v4, v5
v_mul_u32_u24 v4, 4160, v4
v_lshlrev_b32 v5, 4, v3
v_add_u32 v24, v4, v5
s_mul_i32 s63, s57, 332800
s_lshl_b32 s64, s56, 7
s_add_u32 s63, s63, s64
s_lshr_b32 s64, s52, 1
s_lshl_b32 s64, s64, 6
s_add_u32 s63, s63, s64
s_add_u32 s63, s63, 2818048
v_mul_u32_u24 v8, 1280, v2
v_mul_u32_u24 v5, 40, v3
v_add_u32 v8, v8, v5
s_lshl_b32 s64, s56, 2
s_add_u32 s64, s64, s52
s_mul_i32 s64, s64, 20480
s_mul_i32 s65, s57, 160
s_add_u32 s64, s64, s65
s_and_b32 s65, s52, 1
s_lshl_b32 s65, s65, 4
v_add_u32 v14, s65, v2
v_lshlrev_b32 v5, 3, v3
v_sub_u32 v5, v14, v5
v_mov_b32 v14, 0x3f80
v_mov_b32 v15, 0x3f800000
v_cmp_eq_u32 vcc, 0, v5
s_nop 1
v_cndmask_b32 v10, 0, v14, vcc
v_cmp_eq_u32 vcc, 1, v5
s_nop 1
v_cndmask_b32 v10, v10, v15, vcc
v_cmp_eq_u32 vcc, 2, v5
s_nop 1
v_cndmask_b32 v11, 0, v14, vcc
v_cmp_eq_u32 vcc, 3, v5
s_nop 1
v_cndmask_b32 v11, v11, v15, vcc
v_cmp_eq_u32 vcc, 4, v5
s_nop 1
v_cndmask_b32 v12, 0, v14, vcc
v_cmp_eq_u32 vcc, 5, v5
s_nop 1
v_cndmask_b32 v12, v12, v15, vcc
v_cmp_eq_u32 vcc, 6, v5
s_nop 1
v_cndmask_b32 v13, 0, v14, vcc
v_cmp_eq_u32 vcc, 7, v5
s_nop 1
v_cndmask_b32 v13, v13, v15, vcc
s_mul_i32 s70, s67, 15
s_add_u32 s70, s70, 0
v_add_u32 v20, s70, v6
s_mul_i32 s70, s68, 15
s_add_u32 s70, s70, 5120
v_add_u32 v21, s70, v6
s_mul_i32 s70, s69, 15
s_add_u32 s70, s70, 10240
v_add_u32 v22, s70, v6
s_mul_i32 s70, s66, 15
v_add_u32 v23, s70, v6
v_mov_b32 v26, 0
v_min_u32 v25, 15, v1
v_lshlrev_b32 v25, 7, v25
v_lshlrev_b32 v2, 7, v1
s_mul_i32 s71, s57, 10240
s_add_u32 s71, s71, 13762560
s_add_u32 s72, s71, 8192
v_min_u32 v3, 11, v1
v_lshlrev_b32 v3, 7, v3
s_mul_i32 s73, s57, 48
s_add_u32 s73, s73, s58
s_lshl_b32 s73, s73, 7
s_add_u32 s73, s73, 13893632
v_and_b32 v4, 3, v1
v_lshlrev_b32 v4, 7, v4
v_bfe_u32 v5, v1, 2, 1
v_lshlrev_b32 v5, 2, v5
v_add_u32 v4, v4, v5
s_lshr_b32 s74, s56, 1
s_lshl_b32 s74, s74, 4
s_lshl_b32 s75, s52, 2
s_add_u32 s74, s74, s75
s_lshl_b32 s74, s74, 7
s_and_b32 s75, s56, 1
s_lshl_b32 s75, s75, 3
s_add_u32 s74, s74, s75
s_add_u32 s74, s74, 13959168
v_mov_b32 v253, s76
s_waitcnt vmcnt(0)
s_mov_b64 exec, 1
buffer_store_dword v253, v26, s[36:39], s79 offen sc0 sc1
s_andn2_b32 s79, s79, 127
buffer_store_dword v253, v26, s[36:39], s79 offen offset:64 sc0 sc1
s_mov_b64 exec, -1
v_cmp_ne_u32 vcc, s76, v252
s_nop 1
s_cmp_eq_u64 vcc, 0
s_cbranch_scc1 L_wok_29
s_mov_b32 s98, 200000
L_fpw_30:
buffer_load_dword v27, v3, s[36:39], s73 offen sc0 sc1
s_waitcnt vmcnt(0)
v_cmp_ne_u32 vcc, s76, v27
s_nop 1
s_cmp_eq_u64 vcc, 0
s_cbranch_scc1 L_fpdw_31
s_sub_u32 s98, s98, 1
s_cmp_eq_u32 s98, 0
s_cbranch_scc1 L_fpdw_31
s_sleep 2
s_branch L_fpw_30
L_fpdw_31:
L_wok_29:
s_add_u32 s61, s60, 0
s_add_u32 s62, s59, 0
buffer_load_dwordx4 v[108:111], v6, s[36:39], s61 offen offset:0 sc0 sc1
buffer_load_dwordx4 v[112:115], v6, s[36:39], s61 offen offset:1024 sc0 sc1
buffer_load_dwordx4 v[116:119], v6, s[36:39], s61 offen offset:2048 sc0 sc1
buffer_load_dwordx4 v[120:123], v6, s[36:39], s61 offen offset:3072 sc0 sc1
buffer_load_dwordx4 v[124:127], v7, s[36:39], s61 offen sc0 sc1
s_add_u32 s61, s60, 5120
s_add_u32 s62, s59, 4096
buffer_load_dwordx4 v[144:147], v6, s[36:39], s61 offen offset:0 sc0 sc1
buffer_load_dwordx4 v[148:151], v6, s[36:39], s61 offen offset:1024 sc0 sc1
buffer_load_dwordx4 v[152:155], v6, s[36:39], s61 offen offset:2048 sc0 sc1
buffer_load_dwordx4 v[156:159], v6, s[36:39], s61 offen offset:3072 sc0 sc1
buffer_load_dwordx4 v[160:163], v7, s[36:39], s61 offen sc0 sc1
s_add_u32 s61, s60, 10240
s_add_u32 s62, s59, 8192
buffer_load_dwordx4 v[180:183], v6, s[36:39], s61 offen offset:0 sc0 sc1
buffer_load_dwordx4 v[184:187], v6, s[36:39], s61 offen offset:1024 sc0 sc1
buffer_load_dwordx4 v[188:191], v6, s[36:39], s61 offen offset:2048 sc0 sc1
buffer_load_dwordx4 v[192:195], v6, s[36:39], s61 offen offset:3072 sc0 sc1
buffer_load_dwordx4 v[196:199], v7, s[36:39], s61 offen sc0 sc1
s_mov_b32 s98, 200000
L_fpa_32:
buffer_load_dword v27, v4, s[36:39], s74 offen sc0 sc1
s_waitcnt vmcnt(0)
v_cmp_ne_u32 vcc, s76, v27
s_nop 1
s_cmp_eq_u64 vcc, 0
s_cbranch_scc1 L_fpda_33
s_sub_u32 s98, s98, 1
s_cmp_eq_u32 s98, 0
s_cbranch_scc1 L_fpda_33
s_sleep 2
s_branch L_fpa_32
L_fpda_33:
s_add_u32 s61, s60, 0
s_add_u32 s62, s59, 0
buffer_load_dwordx4 v[128:131], v16, s[36:39], s62 offen sc0 sc1
buffer_load_dwordx4 v[132:135], v17, s[36:39], s62 offen sc0 sc1
buffer_load_dwordx4 v[136:139], v18, s[36:39], s62 offen sc0 sc1
buffer_load_dwordx4 v[140:143], v19, s[36:39], s62 offen sc0 sc1
s_add_u32 s61, s60, 5120
s_add_u32 s62, s59, 4096
buffer_load_dwordx4 v[164:167], v16, s[36:39], s62 offen sc0 sc1
buffer_load_dwordx4 v[168:171], v17, s[36:39], s62 offen sc0 sc1
buffer_load_dwordx4 v[172:175], v18, s[36:39], s62 offen sc0 sc1
buffer_load_dwordx4 v[176:179], v19, s[36:39], s62 offen sc0 sc1
s_add_u32 s61, s60, 10240
s_add_u32 s62, s59, 8192
buffer_load_dwordx4 v[200:203], v16, s[36:39], s62 offen sc0 sc1
buffer_load_dwordx4 v[204:207], v17, s[36:39], s62 offen sc0 sc1
buffer_load_dwordx4 v[208:211], v18, s[36:39], s62 offen sc0 sc1
buffer_load_dwordx4 v[212:215], v19, s[36:39], s62 offen sc0 sc1
s_waitcnt vmcnt(8)
v_mfma_f32_16x16x32_bf16 v[28:31], v[108:111], v[128:131], v[28:31]
v_mfma_f32_16x16x32_bf16 v[32:35], v[108:111], v[132:135], v[32:35]
s_add_u32 s61, s60, 15360
s_add_u32 s62, s59, 12288
buffer_load_dwordx4 v[216:219], v6, s[36:39], s61 offen offset:0 sc0 sc1
v_mfma_f32_16x16x32_bf16 v[36:39], v[108:111], v[136:139], v[36:39]
v_mfma_f32_16x16x32_bf16 v[40:43], v[108:111], v[140:143], v[40:43]
buffer_load_dwordx4 v[236:239], v16, s[36:39], s62 offen sc0 sc1
v_mfma_f32_16x16x32_bf16 v[44:47], v[112:115], v[128:131], v[44:47]
v_mfma_f32_16x16x32_bf16 v[48:51], v[112:115], v[132:135], v[48:51]
buffer_load_dwordx4 v[240:243], v17, s[36:39], s62 offen sc0 sc1
v_mfma_f32_16x16x32_bf16 v[52:55], v[112:115], v[136:139], v[52:55]
v_mfma_f32_16x16x32_bf16 v[56:59], v[112:115], v[140:143], v[56:59]
buffer_load_dwordx4 v[220:223], v6, s[36:39], s61 offen offset:1024 sc0 sc1
v_mfma_f32_16x16x32_bf16 v[60:63], v[116:119], v[128:131], v[60:63]
v_mfma_f32_16x16x32_bf16 v[64:67], v[116:119], v[132:135], v[64:67]
buffer_load_dwordx4 v[244:247], v18, s[36:39], s62 offen sc0 sc1
v_mfma_f32_16x16x32_bf16 v[68:71], v[116:119], v[136:139], v[68:71]
v_mfma_f32_16x16x32_bf16 v[72:75], v[116:119], v[140:143], v[72:75]
buffer_load_dwordx4 v[248:251], v19, s[36:39], s62 offen sc0 sc1
v_mfma_f32_16x16x32_bf16 v[76:79], v[120:123], v[128:131], v[76:79]
v_mfma_f32_16x16x32_bf16 v[80:83], v[120:123], v[132:135], v[80:83]
buffer_load_dwordx4 v[224:227], v6, s[36:39], s61 offen offset:2048 sc0 sc1
v_mfma_f32_16x16x32_bf16 v[84:87], v[120:123], v[136:139], v[84:87]
v_mfma_f32_16x16x32_bf16 v[88:91], v[120:123], v[140:143], v[88:91]
buffer_load_dwordx4 v[228:231], v6, s[36:39], s61 offen offset:3072 sc0 sc1
v_mfma_f32_16x16x32_bf16 v[92:95], v[124:127], v[128:131], v[92:95]
v_mfma_f32_16x16x32_bf16 v[96:99], v[124:127], v[132:135], v[96:99]
buffer_load_dwordx4 v[232:235], v7, s[36:39], s61 offen sc0 sc1
v_mfma_f32_16x16x32_bf16 v[100:103], v[124:127], v[136:139], v[100:103]
v_mfma_f32_16x16x32_bf16 v[104:107], v[124:127], v[140:143], v[104:107]
s_waitcnt vmcnt(13)
v_mfma_f32_16x16x32_bf16 v[28:31], v[144:147], v[164:167], v[28:31]
v_mfma_f32_16x16x32_bf16 v[32:35], v[144:147], v[168:171], v[32:35]
s_add_u32 s61, s60, 20480
s_add_u32 s62, s59, 16384
buffer_load_dwordx4 v[108:111], v6, s[36:39], s61 offen offset:0 sc0 sc1
v_mfma_f32_16x16x32_bf16 v[36:39], v[144:147], v[172:175], v[36:39]
v_mfma_f32_16x16x32_bf16 v[40:43], v[144:147], v[176:179], v[40:43]
buffer_load_dwordx4 v[128:131], v16, s[36:39], s62 offen sc0 sc1
v_mfma_f32_16x16x32_bf16 v[44:47], v[148:151], v[164:167], v[44:47]
v_mfma_f32_16x16x32_bf16 v[48:51], v[148:151], v[168:171], v[48:51]
buffer_load_dwordx4 v[132:135], v17, s[36:39], s62 offen sc0 sc1
v_mfma_f32_16x16x32_bf16 v[52:55], v[148:151], v[172:175], v[52:55]
v_mfma_f32_16x16x32_bf16 v[56:59], v[148:151], v[176:179], v[56:59]
buffer_load_dwordx4 v[112:115], v6, s[36:39], s61 offen offset:1024 sc0 sc1
v_mfma_f32_16x16x32_bf16 v[60:63], v[152:155], v[164:167], v[60:63]
v_mfma_f32_16x16x32_bf16 v[64:67], v[152:155], v[168:171], v[64:67]
buffer_load_dwordx4 v[136:139], v18, s[36:39], s62 offen sc0 sc1
v_mfma_f32_16x16x32_bf16 v[68:71], v[152:155], v[172:175], v[68:71]
v_mfma_f32_16x16x32_bf16 v[72:75], v[152:155], v[176:179], v[72:75]
buffer_load_dwordx4 v[140:143], v19, s[36:39], s62 offen sc0 sc1
v_mfma_f32_16x16x32_bf16 v[76:79], v[156:159], v[164:167], v[76:79]
v_mfma_f32_16x16x32_bf16 v[80:83], v[156:159], v[168:171], v[80:83]
buffer_load_dwordx4 v[116:119], v6, s[36:39], s61 offen offset:2048 sc0 sc1
v_mfma_f32_16x16x32_bf16 v[84:87], v[156:159], v[172:175], v[84:87]
v_mfma_f32_16x16x32_bf16 v[88:91], v[156:159], v[176:179], v[88:91]
buffer_load_dwordx4 v[120:123], v6, s[36:39], s61 offen offset:3072 sc0 sc1
v_mfma_f32_16x16x32_bf16 v[92:95], v[160:163], v[164:167], v[92:95]
v_mfma_f32_16x16x32_bf16 v[96:99], v[160:163], v[168:171], v[96:99]
buffer_load_dwordx4 v[124:127], v7, s[36:39], s61 offen sc0 sc1
v_mfma_f32_16x16x32_bf16 v[100:103], v[160:163], v[172:175], v[100:103]
v_mfma_f32_16x16x32_bf16 v[104:107], v[160:163], v[176:179], v[104:107]
s_waitcnt vmcnt(18)
v_mfma_f32_16x16x32_bf16 v[28:31], v[180:183], v[200:203], v[28:31]
v_mfma_f32_16x16x32_bf16 v[32:35], v[180:183], v[204:207], v[32:35]
s_add_u32 s61, s60, 25600
s_add_u32 s62, s59, 20480
buffer_load_dwordx4 v[144:147], v6, s[36:39], s61 offen offset:0 sc0 sc1
v_mfma_f32_16x16x32_bf16 v[36:39], v[180:183], v[208:211], v[36:39]
v_mfma_f32_16x16x32_bf16 v[40:43], v[180:183], v[212:215], v[40:43]
buffer_load_dwordx4 v[164:167], v16, s[36:39], s62 offen sc0 sc1
v_mfma_f32_16x16x32_bf16 v[44:47], v[184:187], v[200:203], v[44:47]
v_mfma_f32_16x16x32_bf16 v[48:51], v[184:187], v[204:207], v[48:51]
buffer_load_dwordx4 v[168:171], v17, s[36:39], s62 offen sc0 sc1
v_mfma_f32_16x16x32_bf16 v[52:55], v[184:187], v[208:211], v[52:55]
v_mfma_f32_16x16x32_bf16 v[56:59], v[184:187], v[212:215], v[56:59]
buffer_load_dwordx4 v[148:151], v6, s[36:39], s61 offen offset:1024 sc0 sc1
v_mfma_f32_16x16x32_bf16 v[60:63], v[188:191], v[200:203], v[60:63]
v_mfma_f32_16x16x32_bf16 v[64:67], v[188:191], v[204:207], v[64:67]
buffer_load_dwordx4 v[172:175], v18, s[36:39], s62 offen sc0 sc1
v_mfma_f32_16x16x32_bf16 v[68:71], v[188:191], v[208:211], v[68:71]
v_mfma_f32_16x16x32_bf16 v[72:75], v[188:191], v[212:215], v[72:75]
buffer_load_dwordx4 v[176:179], v19, s[36:39], s62 offen sc0 sc1
v_mfma_f32_16x16x32_bf16 v[76:79], v[192:195], v[200:203], v[76:79]
v_mfma_f32_16x16x32_bf16 v[80:83], v[192:195], v[204:207], v[80:83]
buffer_load_dwordx4 v[152:155], v6, s[36:39], s61 offen offset:2048 sc0 sc1
v_mfma_f32_16x16x32_bf16 v[84:87], v[192:195], v[208:211], v[84:87]
v_mfma_f32_16x16x32_bf16 v[88:91], v[192:195], v[212:215], v[88:91]
buffer_load_dwordx4 v[156:159], v6, s[36:39], s61 offen offset:3072 sc0 sc1
v_mfma_f32_16x16x32_bf16 v[92:95], v[196:199], v[200:203], v[92:95]
v_mfma_f32_16x16x32_bf16 v[96:99], v[196:199], v[204:207], v[96:99]
buffer_load_dwordx4 v[160:163], v7, s[36:39], s61 offen sc0 sc1
v_mfma_f32_16x16x32_bf16 v[100:103], v[196:199], v[208:211], v[100:103]
v_mfma_f32_16x16x32_bf16 v[104:107], v[196:199], v[212:215], v[104:107]
s_waitcnt vmcnt(18)
v_mfma_f32_16x16x32_bf16 v[28:31], v[216:219], v[236:239], v[28:31]
v_mfma_f32_16x16x32_bf16 v[32:35], v[216:219], v[240:243], v[32:35]
s_add_u32 s61, s60, 30720
s_add_u32 s62, s59, 24576
buffer_load_dwordx4 v[180:183], v6, s[36:39], s61 offen offset:0 sc0 sc1
v_mfma_f32_16x16x32_bf16 v[36:39], v[216:219], v[244:247], v[36:39]
v_mfma_f32_16x16x32_bf16 v[40:43], v[216:219], v[248:251], v[40:43]
buffer_load_dwordx4 v[200:203], v16, s[36:39], s62 offen sc0 sc1
v_mfma_f32_16x16x32_bf16 v[44:47], v[220:223], v[236:239], v[44:47]
v_mfma_f32_16x16x32_bf16 v[48:51], v[220:223], v[240:243], v[48:51]
buffer_load_dwordx4 v[204:207], v17, s[36:39], s62 offen sc0 sc1
v_mfma_f32_16x16x32_bf16 v[52:55], v[220:223], v[244:247], v[52:55]
v_mfma_f32_16x16x32_bf16 v[56:59], v[220:223], v[248:251], v[56:59]
buffer_load_dwordx4 v[184:187], v6, s[36:39], s61 offen offset:1024 sc0 sc1
v_mfma_f32_16x16x32_bf16 v[60:63], v[224:227], v[236:239], v[60:63]
v_mfma_f32_16x16x32_bf16 v[64:67], v[224:227], v[240:243], v[64:67]
buffer_load_dwordx4 v[208:211], v18, s[36:39], s62 offen sc0 sc1
v_mfma_f32_16x16x32_bf16 v[68:71], v[224:227], v[244:247], v[68:71]
v_mfma_f32_16x16x32_bf16 v[72:75], v[224:227], v[248:251], v[72:75]
buffer_load_dwordx4 v[212:215], v19, s[36:39], s62 offen sc0 sc1
v_mfma_f32_16x16x32_bf16 v[76:79], v[228:231], v[236:239], v[76:79]
v_mfma_f32_16x16x32_bf16 v[80:83], v[228:231], v[240:243], v[80:83]
buffer_load_dwordx4 v[188:191], v6, s[36:39], s61 offen offset:2048 sc0 sc1
v_mfma_f32_16x16x32_bf16 v[84:87], v[228:231], v[244:247], v[84:87]
v_mfma_f32_16x16x32_bf16 v[88:91], v[228:231], v[248:251], v[88:91]
buffer_load_dwordx4 v[192:195], v6, s[36:39], s61 offen offset:3072 sc0 sc1
v_mfma_f32_16x16x32_bf16 v[92:95], v[232:235], v[236:239], v[92:95]
v_mfma_f32_16x16x32_bf16 v[96:99], v[232:235], v[240:243], v[96:99]
buffer_load_dwordx4 v[196:199], v7, s[36:39], s61 offen sc0 sc1
v_mfma_f32_16x16x32_bf16 v[100:103], v[232:235], v[244:247], v[100:103]
v_mfma_f32_16x16x32_bf16 v[104:107], v[232:235], v[248:251], v[104:107]
s_waitcnt vmcnt(18)
v_mfma_f32_16x16x32_bf16 v[28:31], v[108:111], v[128:131], v[28:31]
v_mfma_f32_16x16x32_bf16 v[32:35], v[108:111], v[132:135], v[32:35]
s_add_u32 s61, s60, 35840
s_add_u32 s62, s59, 28672
buffer_load_dwordx4 v[216:219], v6, s[36:39], s61 offen offset:0 sc0 sc1
v_mfma_f32_16x16x32_bf16 v[36:39], v[108:111], v[136:139], v[36:39]
v_mfma_f32_16x16x32_bf16 v[40:43], v[108:111], v[140:143], v[40:43]
buffer_load_dwordx4 v[236:239], v16, s[36:39], s62 offen sc0 sc1
v_mfma_f32_16x16x32_bf16 v[44:47], v[112:115], v[128:131], v[44:47]
v_mfma_f32_16x16x32_bf16 v[48:51], v[112:115], v[132:135], v[48:51]
buffer_load_dwordx4 v[240:243], v17, s[36:39], s62 offen sc0 sc1
v_mfma_f32_16x16x32_bf16 v[52:55], v[112:115], v[136:139], v[52:55]
v_mfma_f32_16x16x32_bf16 v[56:59], v[112:115], v[140:143], v[56:59]
buffer_load_dwordx4 v[220:223], v6, s[36:39], s61 offen offset:1024 sc0 sc1
v_mfma_f32_16x16x32_bf16 v[60:63], v[116:119], v[128:131], v[60:63]
v_mfma_f32_16x16x32_bf16 v[64:67], v[116:119], v[132:135], v[64:67]
buffer_load_dwordx4 v[244:247], v18, s[36:39], s62 offen sc0 sc1
v_mfma_f32_16x16x32_bf16 v[68:71], v[116:119], v[136:139], v[68:71]
v_mfma_f32_16x16x32_bf16 v[72:75], v[116:119], v[140:143], v[72:75]
buffer_load_dwordx4 v[248:251], v19, s[36:39], s62 offen sc0 sc1
v_mfma_f32_16x16x32_bf16 v[76:79], v[120:123], v[128:131], v[76:79]
v_mfma_f32_16x16x32_bf16 v[80:83], v[120:123], v[132:135], v[80:83]
buffer_load_dwordx4 v[224:227], v6, s[36:39], s61 offen offset:2048 sc0 sc1
v_mfma_f32_16x16x32_bf16 v[84:87], v[120:123], v[136:139], v[84:87]
v_mfma_f32_16x16x32_bf16 v[88:91], v[120:123], v[140:143], v[88:91]
buffer_load_dwordx4 v[228:231], v6, s[36:39], s61 offen offset:3072 sc0 sc1
v_mfma_f32_16x16x32_bf16 v[92:95], v[124:127], v[128:131], v[92:95]
v_mfma_f32_16x16x32_bf16 v[96:99], v[124:127], v[132:135], v[96:99]
buffer_load_dwordx4 v[232:235], v7, s[36:39], s61 offen sc0 sc1
v_mfma_f32_16x16x32_bf16 v[100:103], v[124:127], v[136:139], v[100:103]
v_mfma_f32_16x16x32_bf16 v[104:107], v[124:127], v[140:143], v[104:107]
s_waitcnt vmcnt(18)
v_mfma_f32_16x16x32_bf16 v[28:31], v[144:147], v[164:167], v[28:31]
v_mfma_f32_16x16x32_bf16 v[32:35], v[144:147], v[168:171], v[32:35]
s_add_u32 s61, s60, 40960
s_add_u32 s62, s59, 32768
buffer_load_dwordx4 v[108:111], v6, s[36:39], s61 offen offset:0 sc0 sc1
v_mfma_f32_16x16x32_bf16 v[36:39], v[144:147], v[172:175], v[36:39]
v_mfma_f32_16x16x32_bf16 v[40:43], v[144:147], v[176:179], v[40:43]
buffer_load_dwordx4 v[128:131], v16, s[36:39], s62 offen sc0 sc1
v_mfma_f32_16x16x32_bf16 v[44:47], v[148:151], v[164:167], v[44:47]
v_mfma_f32_16x16x32_bf16 v[48:51], v[148:151], v[168:171], v[48:51]
buffer_load_dwordx4 v[132:135], v17, s[36:39], s62 offen sc0 sc1
v_mfma_f32_16x16x32_bf16 v[52:55], v[148:151], v[172:175], v[52:55]
v_mfma_f32_16x16x32_bf16 v[56:59], v[148:151], v[176:179], v[56:59]
buffer_load_dwordx4 v[112:115], v6, s[36:39], s61 offen offset:1024 sc0 sc1
v_mfma_f32_16x16x32_bf16 v[60:63], v[152:155], v[164:167], v[60:63]
v_mfma_f32_16x16x32_bf16 v[64:67], v[152:155], v[168:171], v[64:67]
buffer_load_dwordx4 v[136:139], v18, s[36:39], s62 offen sc0 sc1
v_mfma_f32_16x16x32_bf16 v[68:71], v[152:155], v[172:175], v[68:71]
v_mfma_f32_16x16x32_bf16 v[72:75], v[152:155], v[176:179], v[72:75]
buffer_load_dwordx4 v[140:143], v19, s[36:39], s62 offen sc0 sc1
v_mfma_f32_16x16x32_bf16 v[76:79], v[156:159], v[164:167], v[76:79]
v_mfma_f32_16x16x32_bf16 v[80:83], v[156:159], v[168:171], v[80:83]
buffer_load_dwordx4 v[116:119], v6, s[36:39], s61 offen offset:2048 sc0 sc1
v_mfma_f32_16x16x32_bf16 v[84:87], v[156:159], v[172:175], v[84:87]
v_mfma_f32_16x16x32_bf16 v[88:91], v[156:159], v[176:179], v[88:91]
buffer_load_dwordx4 v[120:123], v6, s[36:39], s61 offen offset:3072 sc0 sc1
v_mfma_f32_16x16x32_bf16 v[92:95], v[160:163], v[164:167], v[92:95]
v_mfma_f32_16x16x32_bf16 v[96:99], v[160:163], v[168:171], v[96:99]
buffer_load_dwordx4 v[124:127], v7, s[36:39], s61 offen sc0 sc1
v_mfma_f32_16x16x32_bf16 v[100:103], v[160:163], v[172:175], v[100:103]
v_mfma_f32_16x16x32_bf16 v[104:107], v[160:163], v[176:179], v[104:107]
s_waitcnt vmcnt(18)
v_mfma_f32_16x16x32_bf16 v[28:31], v[180:183], v[200:203], v[28:31]
v_mfma_f32_16x16x32_bf16 v[32:35], v[180:183], v[204:207], v[32:35]
s_add_u32 s61, s60, 46080
s_add_u32 s62, s59, 36864
buffer_load_dwordx4 v[144:147], v6, s[36:39], s61 offen offset:0 sc0 sc1
v_mfma_f32_16x16x32_bf16 v[36:39], v[180:183], v[208:211], v[36:39]
v_mfma_f32_16x16x32_bf16 v[40:43], v[180:183], v[212:215], v[40:43]
buffer_load_dwordx4 v[164:167], v16, s[36:39], s62 offen sc0 sc1
v_mfma_f32_16x16x32_bf16 v[44:47], v[184:187], v[200:203], v[44:47]
v_mfma_f32_16x16x32_bf16 v[48:51], v[184:187], v[204:207], v[48:51]
buffer_load_dwordx4 v[168:171], v17, s[36:39], s62 offen sc0 sc1
v_mfma_f32_16x16x32_bf16 v[52:55], v[184:187], v[208:211], v[52:55]
v_mfma_f32_16x16x32_bf16 v[56:59], v[184:187], v[212:215], v[56:59]
buffer_load_dwordx4 v[148:151], v6, s[36:39], s61 offen offset:1024 sc0 sc1
v_mfma_f32_16x16x32_bf16 v[60:63], v[188:191], v[200:203], v[60:63]
v_mfma_f32_16x16x32_bf16 v[64:67], v[188:191], v[204:207], v[64:67]
buffer_load_dwordx4 v[172:175], v18, s[36:39], s62 offen sc0 sc1
v_mfma_f32_16x16x32_bf16 v[68:71], v[188:191], v[208:211], v[68:71]
v_mfma_f32_16x16x32_bf16 v[72:75], v[188:191], v[212:215], v[72:75]
buffer_load_dwordx4 v[176:179], v19, s[36:39], s62 offen sc0 sc1
v_mfma_f32_16x16x32_bf16 v[76:79], v[192:195], v[200:203], v[76:79]
v_mfma_f32_16x16x32_bf16 v[80:83], v[192:195], v[204:207], v[80:83]
buffer_load_dwordx4 v[152:155], v6, s[36:39], s61 offen offset:2048 sc0 sc1
v_mfma_f32_16x16x32_bf16 v[84:87], v[192:195], v[208:211], v[84:87]
v_mfma_f32_16x16x32_bf16 v[88:91], v[192:195], v[212:215], v[88:91]
buffer_load_dwordx4 v[156:159], v6, s[36:39], s61 offen offset:3072 sc0 sc1
v_mfma_f32_16x16x32_bf16 v[92:95], v[196:199], v[200:203], v[92:95]
v_mfma_f32_16x16x32_bf16 v[96:99], v[196:199], v[204:207], v[96:99]
buffer_load_dwordx4 v[160:163], v7, s[36:39], s61 offen sc0 sc1
v_mfma_f32_16x16x32_bf16 v[100:103], v[196:199], v[208:211], v[100:103]
v_mfma_f32_16x16x32_bf16 v[104:107], v[196:199], v[212:215], v[104:107]
s_waitcnt vmcnt(18)
v_mfma_f32_16x16x32_bf16 v[28:31], v[216:219], v[236:239], v[28:31]
v_mfma_f32_16x16x32_bf16 v[32:35], v[216:219], v[240:243], v[32:35]
s_add_u32 s61, s60, 51200
s_add_u32 s62, s59, 40960
buffer_load_dwordx4 v[180:183], v6, s[36:39], s61 offen offset:0 sc0 sc1
v_mfma_f32_16x16x32_bf16 v[36:39], v[216:219], v[244:247], v[36:39]
v_mfma_f32_16x16x32_bf16 v[40:43], v[216:219], v[248:251], v[40:43]
buffer_load_dwordx4 v[200:203], v16, s[36:39], s62 offen sc0 sc1
v_mfma_f32_16x16x32_bf16 v[44:47], v[220:223], v[236:239], v[44:47]
v_mfma_f32_16x16x32_bf16 v[48:51], v[220:223], v[240:243], v[48:51]
buffer_load_dwordx4 v[204:207], v17, s[36:39], s62 offen sc0 sc1
v_mfma_f32_16x16x32_bf16 v[52:55], v[220:223], v[244:247], v[52:55]
v_mfma_f32_16x16x32_bf16 v[56:59], v[220:223], v[248:251], v[56:59]
buffer_load_dwordx4 v[184:187], v6, s[36:39], s61 offen offset:1024 sc0 sc1
v_mfma_f32_16x16x32_bf16 v[60:63], v[224:227], v[236:239], v[60:63]
v_mfma_f32_16x16x32_bf16 v[64:67], v[224:227], v[240:243], v[64:67]
buffer_load_dwordx4 v[208:211], v18, s[36:39], s62 offen sc0 sc1
v_mfma_f32_16x16x32_bf16 v[68:71], v[224:227], v[244:247], v[68:71]
v_mfma_f32_16x16x32_bf16 v[72:75], v[224:227], v[248:251], v[72:75]
buffer_load_dwordx4 v[212:215], v19, s[36:39], s62 offen sc0 sc1
v_mfma_f32_16x16x32_bf16 v[76:79], v[228:231], v[236:239], v[76:79]
v_mfma_f32_16x16x32_bf16 v[80:83], v[228:231], v[240:243], v[80:83]
buffer_load_dwordx4 v[188:191], v6, s[36:39], s61 offen offset:2048 sc0 sc1
v_mfma_f32_16x16x32_bf16 v[84:87], v[228:231], v[244:247], v[84:87]
v_mfma_f32_16x16x32_bf16 v[88:91], v[228:231], v[248:251], v[88:91]
buffer_load_dwordx4 v[192:195], v6, s[36:39], s61 offen offset:3072 sc0 sc1
v_mfma_f32_16x16x32_bf16 v[92:95], v[232:235], v[236:239], v[92:95]
v_mfma_f32_16x16x32_bf16 v[96:99], v[232:235], v[240:243], v[96:99]
buffer_load_dwordx4 v[196:199], v7, s[36:39], s61 offen sc0 sc1
v_mfma_f32_16x16x32_bf16 v[100:103], v[232:235], v[244:247], v[100:103]
v_mfma_f32_16x16x32_bf16 v[104:107], v[232:235], v[248:251], v[104:107]
s_waitcnt vmcnt(18)
v_mfma_f32_16x16x32_bf16 v[28:31], v[108:111], v[128:131], v[28:31]
v_mfma_f32_16x16x32_bf16 v[32:35], v[108:111], v[132:135], v[32:35]
s_add_u32 s61, s60, 56320
s_add_u32 s62, s59, 45056
buffer_load_dwordx4 v[216:219], v6, s[36:39], s61 offen offset:0 sc0 sc1
v_mfma_f32_16x16x32_bf16 v[36:39], v[108:111], v[136:139], v[36:39]
v_mfma_f32_16x16x32_bf16 v[40:43], v[108:111], v[140:143], v[40:43]
buffer_load_dwordx4 v[236:239], v16, s[36:39], s62 offen sc0 sc1
v_mfma_f32_16x16x32_bf16 v[44:47], v[112:115], v[128:131], v[44:47]
v_mfma_f32_16x16x32_bf16 v[48:51], v[112:115], v[132:135], v[48:51]
buffer_load_dwordx4 v[240:243], v17, s[36:39], s62 offen sc0 sc1
v_mfma_f32_16x16x32_bf16 v[52:55], v[112:115], v[136:139], v[52:55]
v_mfma_f32_16x16x32_bf16 v[56:59], v[112:115], v[140:143], v[56:59]
buffer_load_dwordx4 v[220:223], v6, s[36:39], s61 offen offset:1024 sc0 sc1
v_mfma_f32_16x16x32_bf16 v[60:63], v[116:119], v[128:131], v[60:63]
v_mfma_f32_16x16x32_bf16 v[64:67], v[116:119], v[132:135], v[64:67]
buffer_load_dwordx4 v[244:247], v18, s[36:39], s62 offen sc0 sc1
v_mfma_f32_16x16x32_bf16 v[68:71], v[116:119], v[136:139], v[68:71]
v_mfma_f32_16x16x32_bf16 v[72:75], v[116:119], v[140:143], v[72:75]
buffer_load_dwordx4 v[248:251], v19, s[36:39], s62 offen sc0 sc1
v_mfma_f32_16x16x32_bf16 v[76:79], v[120:123], v[128:131], v[76:79]
v_mfma_f32_16x16x32_bf16 v[80:83], v[120:123], v[132:135], v[80:83]
buffer_load_dwordx4 v[224:227], v6, s[36:39], s61 offen offset:2048 sc0 sc1
v_mfma_f32_16x16x32_bf16 v[84:87], v[120:123], v[136:139], v[84:87]
v_mfma_f32_16x16x32_bf16 v[88:91], v[120:123], v[140:143], v[88:91]
buffer_load_dwordx4 v[228:231], v6, s[36:39], s61 offen offset:3072 sc0 sc1
v_mfma_f32_16x16x32_bf16 v[92:95], v[124:127], v[128:131], v[92:95]
v_mfma_f32_16x16x32_bf16 v[96:99], v[124:127], v[132:135], v[96:99]
buffer_load_dwordx4 v[232:235], v7, s[36:39], s61 offen sc0 sc1
v_mfma_f32_16x16x32_bf16 v[100:103], v[124:127], v[136:139], v[100:103]
v_mfma_f32_16x16x32_bf16 v[104:107], v[124:127], v[140:143], v[104:107]
s_waitcnt vmcnt(18)
v_mfma_f32_16x16x32_bf16 v[28:31], v[144:147], v[164:167], v[28:31]
v_mfma_f32_16x16x32_bf16 v[32:35], v[144:147], v[168:171], v[32:35]
buffer_load_dwordx4 v[108:111], v8, s[40:43], s64 offen
v_mfma_f32_16x16x32_bf16 v[36:39], v[144:147], v[172:175], v[36:39]
v_mfma_f32_16x16x32_bf16 v[40:43], v[144:147], v[176:179], v[40:43]
buffer_load_dwordx4 v[112:115], v8, s[40:43], s64 offen offset:16
v_mfma_f32_16x16x32_bf16 v[44:47], v[148:151], v[164:167], v[44:47]
v_mfma_f32_16x16x32_bf16 v[48:51], v[148:151], v[168:171], v[48:51]
buffer_load_dwordx2 v[116:117], v8, s[40:43], s64 offen offset:32
v_mfma_f32_16x16x32_bf16 v[52:55], v[148:151], v[172:175], v[52:55]
v_mfma_f32_16x16x32_bf16 v[56:59], v[148:151], v[176:179], v[56:59]
buffer_load_dword v27, v26, s[48:51], 0 offen sc0 sc1
v_mfma_f32_16x16x32_bf16 v[60:63], v[152:155], v[164:167], v[60:63]
v_mfma_f32_16x16x32_bf16 v[64:67], v[152:155], v[168:171], v[64:67]
v_mfma_f32_16x16x32_bf16 v[68:71], v[152:155], v[172:175], v[68:71]
v_mfma_f32_16x16x32_bf16 v[72:75], v[152:155], v[176:179], v[72:75]
v_mfma_f32_16x16x32_bf16 v[76:79], v[156:159], v[164:167], v[76:79]
v_mfma_f32_16x16x32_bf16 v[80:83], v[156:159], v[168:171], v[80:83]
v_mfma_f32_16x16x32_bf16 v[84:87], v[156:159], v[172:175], v[84:87]
v_mfma_f32_16x16x32_bf16 v[88:91], v[156:159], v[176:179], v[88:91]
v_mfma_f32_16x16x32_bf16 v[92:95], v[160:163], v[164:167], v[92:95]
v_mfma_f32_16x16x32_bf16 v[96:99], v[160:163], v[168:171], v[96:99]
v_mfma_f32_16x16x32_bf16 v[100:103], v[160:163], v[172:175], v[100:103]
v_mfma_f32_16x16x32_bf16 v[104:107], v[160:163], v[176:179], v[104:107]
s_waitcnt vmcnt(13)
v_mfma_f32_16x16x32_bf16 v[28:31], v[180:183], v[200:203], v[28:31]
v_mfma_f32_16x16x32_bf16 v[32:35], v[180:183], v[204:207], v[32:35]
v_mfma_f32_16x16x32_bf16 v[36:39], v[180:183], v[208:211], v[36:39]
v_mfma_f32_16x16x32_bf16 v[40:43], v[180:183], v[212:215], v[40:43]
v_mfma_f32_16x16x32_bf16 v[44:47], v[184:187], v[200:203], v[44:47]
v_mfma_f32_16x16x32_bf16 v[48:51], v[184:187], v[204:207], v[48:51]
v_mfma_f32_16x16x32_bf16 v[52:55], v[184:187], v[208:211], v[52:55]
v_mfma_f32_16x16x32_bf16 v[56:59], v[184:187], v[212:215], v[56:59]
v_mfma_f32_16x16x32_bf16 v[60:63], v[188:191], v[200:203], v[60:63]
v_mfma_f32_16x16x32_bf16 v[64:67], v[188:191], v[204:207], v[64:67]
v_mfma_f32_16x16x32_bf16 v[68:71], v[188:191], v[208:211], v[68:71]
v_mfma_f32_16x16x32_bf16 v[72:75], v[188:191], v[212:215], v[72:75]
v_mfma_f32_16x16x32_bf16 v[76:79], v[192:195], v[200:203], v[76:79]
v_mfma_f32_16x16x32_bf16 v[80:83], v[192:195], v[204:207], v[80:83]
v_mfma_f32_16x16x32_bf16 v[84:87], v[192:195], v[208:211], v[84:87]
v_mfma_f32_16x16x32_bf16 v[88:91], v[192:195], v[212:215], v[88:91]
v_mfma_f32_16x16x32_bf16 v[92:95], v[196:199], v[200:203], v[92:95]
v_mfma_f32_16x16x32_bf16 v[96:99], v[196:199], v[204:207], v[96:99]
v_mfma_f32_16x16x32_bf16 v[100:103], v[196:199], v[208:211], v[100:103]
v_mfma_f32_16x16x32_bf16 v[104:107], v[196:199], v[212:215], v[104:107]
s_waitcnt vmcnt(4)
v_mfma_f32_16x16x32_bf16 v[32:35], v[216:219], v[240:243], v[32:35]
v_mfma_f32_16x16x32_bf16 v[48:51], v[220:223], v[240:243], v[48:51]
buffer_load_dword v164, v2, s[36:39], s71 offen sc0 sc1
v_mfma_f32_16x16x32_bf16 v[64:67], v[224:227], v[240:243], v[64:67]
v_mfma_f32_16x16x32_bf16 v[80:83], v[228:231], v[240:243], v[80:83]
buffer_load_dword v165, v25, s[36:39], s72 offen sc0 sc1
v_mfma_f32_16x16x32_bf16 v[96:99], v[232:235], v[240:243], v[96:99]
v_mfma_f32_16x16x32_bf16 v[36:39], v[216:219], v[244:247], v[36:39]
v_mfma_f32_16x16x32_bf16 v[52:55], v[220:223], v[244:247], v[52:55]
v_mfma_f32_16x16x32_bf16 v[68:71], v[224:227], v[244:247], v[68:71]
v_mfma_f32_16x16x32_bf16 v[84:87], v[228:231], v[244:247], v[84:87]
v_mfma_f32_16x16x32_bf16 v[100:103], v[232:235], v[244:247], v[100:103]
v_mfma_f32_16x16x32_bf16 v[40:43], v[216:219], v[248:251], v[40:43]
ds_write_b128 v20, v[32:35] offset:0
v_mfma_f32_16x16x32_bf16 v[56:59], v[220:223], v[248:251], v[56:59]
ds_write_b128 v20, v[48:51] offset:1024
v_mfma_f32_16x16x32_bf16 v[72:75], v[224:227], v[248:251], v[72:75]
ds_write_b128 v20, v[64:67] offset:2048
v_mfma_f32_16x16x32_bf16 v[88:91], v[228:231], v[248:251], v[88:91]
ds_write_b128 v20, v[80:83] offset:3072
v_mfma_f32_16x16x32_bf16 v[104:107], v[232:235], v[248:251], v[104:107]
ds_write_b128 v20, v[96:99] offset:4096
v_mfma_f32_16x16x32_bf16 v[28:31], v[216:219], v[236:239], v[28:31]
ds_write_b128 v21, v[36:39] offset:0
v_mfma_f32_16x16x32_bf16 v[44:47], v[220:223], v[236:239], v[44:47]
ds_write_b128 v21, v[52:55] offset:1024
v_mfma_f32_16x16x32_bf16 v[60:63], v[224:227], v[236:239], v[60:63]
ds_write_b128 v21, v[68:71] offset:2048
v_mfma_f32_16x16x32_bf16 v[76:79], v[228:231], v[236:239], v[76:79]
ds_write_b128 v21, v[84:87] offset:3072
v_mfma_f32_16x16x32_bf16 v[92:95], v[232:235], v[236:239], v[92:95]
ds_write_b128 v21, v[100:103] offset:4096
s_waitcnt vmcnt(0)
v_readfirstlane_b32 s67, v27
s_mov_b32 s79, 0
s_cmp_eq_u32 s67, 0
s_cbranch_scc1 L_blate_37
v_xor_b32 v164, s67, v164
v_xor_b32 v165, s67, v165
v_or_b32 v164, v164, v165
v_cmp_ne_u32 vcc, 0, v164
s_nop 1
s_cmp_eq_u64 vcc, 0
s_cbranch_scc0 L_blate_37
s_mov_b32 s79, 1
s_add_u32 s73, s63, 0
buffer_load_dwordx4 v[144:147], v24, s[36:39], s73 offen sc0 sc1
s_add_u32 s73, s63, 16640
buffer_load_dwordx4 v[148:151], v24, s[36:39], s73 offen sc0 sc1
s_add_u32 s73, s63, 33280
buffer_load_dwordx4 v[152:155], v24, s[36:39], s73 offen sc0 sc1
s_add_u32 s73, s63, 49920
buffer_load_dwordx4 v[156:159], v24, s[36:39], s73 offen sc0 sc1
s_add_u32 s73, s63, 66560
buffer_load_dwordx4 v[160:163], v24, s[36:39], s73 offen sc0 sc1
L_blate_37:
ds_write_b128 v22, v[40:43] offset:0
ds_write_b128 v22, v[56:59] offset:1024
ds_write_b128 v22, v[72:75] offset:2048
ds_write_b128 v22, v[88:91] offset:3072
ds_write_b128 v22, v[104:107] offset:4096
v_lshlrev_b32 v120, 16, v108
v_and_b32 v121, 0xffff0000, v108
v_lshlrev_b32 v122, 16, v109
v_and_b32 v123, 0xffff0000, v109
v_lshlrev_b32 v124, 16, v110
v_and_b32 v125, 0xffff0000, v110
v_lshlrev_b32 v126, 16, v111
v_and_b32 v127, 0xffff0000, v111
v_lshlrev_b32 v128, 16, v112
v_and_b32 v129, 0xffff0000, v112
v_lshlrev_b32 v130, 16, v113
v_and_b32 v131, 0xffff0000, v113
v_lshlrev_b32 v132, 16, v114
v_and_b32 v133, 0xffff0000, v114
v_lshlrev_b32 v134, 16, v115
v_and_b32 v135, 0xffff0000, v115
v_lshlrev_b32 v136, 16, v116
v_and_b32 v137, 0xffff0000, v116
v_lshlrev_b32 v138, 16, v117
v_and_b32 v139, 0xffff0000, v117
s_mov_b32 s98, 200000
s_waitcnt lgkmcnt(0)
s_barrier
ds_read_b128 v[180:183], v23 offset:0
ds_read_b128 v[184:187], v23 offset:1024
ds_read_b128 v[188:191], v23 offset:2048
ds_read_b128 v[192:195], v23 offset:3072
ds_read_b128 v[196:199], v23 offset:4096
ds_read_b128 v[200:203], v23 offset:5120
ds_read_b128 v[204:207], v23 offset:6144
ds_read_b128 v[208:211], v23 offset:7168
ds_read_b128 v[212:215], v23 offset:8192
ds_read_b128 v[216:219], v23 offset:9216
ds_read_b128 v[220:223], v23 offset:10240
ds_read_b128 v[224:227], v23 offset:11264
ds_read_b128 v[228:231], v23 offset:12288
ds_read_b128 v[232:235], v23 offset:13312
ds_read_b128 v[236:239], v23 offset:14336
s_cmp_eq_u32 s79, 1
s_cbranch_scc1 L_bjoin_38
s_cmp_lg_u32 s67, 0
s_cbranch_scc1 L_bp_35
s_mov_b32 s98, 200000
L_ep_39:
buffer_load_dword v27, v26, s[48:51], 0 offen sc0 sc1
s_waitcnt vmcnt(0)
v_readfirstlane_b32 s67, v27
s_cmp_lg_u32 s67, 0
s_cbranch_scc1 L_epd_40
s_sleep 2
s_sub_u32 s98, s98, 1
s_cmp_lg_u32 s98, 0
s_cbranch_scc1 L_ep_39
L_epd_40:
s_mov_b32 s98, 200000
L_bp_35:
buffer_load_dword v164, v2, s[36:39], s71 offen sc0 sc1
buffer_load_dword v165, v25, s[36:39], s72 offen sc0 sc1
s_waitcnt vmcnt(0)
v_xor_b32 v164, s67, v164
v_xor_b32 v165, s67, v165
v_or_b32 v164, v164, v165
v_cmp_ne_u32 vcc, 0, v164
s_nop 1
s_cmp_eq_u64 vcc, 0
s_cbranch_scc1 L_bpd_36
s_sub_u32 s98, s98, 1
s_cmp_eq_u32 s98, 0
s_cbranch_scc1 L_bpd_36
s_sleep 2
s_branch L_bp_35
L_bpd_36:
s_add_u32 s73, s63, 0
buffer_load_dwordx4 v[144:147], v24, s[36:39], s73 offen sc0 sc1
s_add_u32 s73, s63, 16640
buffer_load_dwordx4 v[148:151], v24, s[36:39], s73 offen sc0 sc1
s_add_u32 s73, s63, 33280
buffer_load_dwordx4 v[152:155], v24, s[36:39], s73 offen sc0 sc1
s_add_u32 s73, s63, 49920
buffer_load_dwordx4 v[156:159], v24, s[36:39], s73 offen sc0 sc1
s_add_u32 s73, s63, 66560
buffer_load_dwordx4 v[160:163], v24, s[36:39], s73 offen sc0 sc1
L_bjoin_38:
s_waitcnt lgkmcnt(10)
v_pk_add_f32 v[120:121], v[120:121], v[180:181]
v_pk_add_f32 v[122:123], v[122:123], v[182:183]
v_pk_add_f32 v[124:125], v[124:125], v[184:185]
v_pk_add_f32 v[126:127], v[126:127], v[186:187]
v_pk_add_f32 v[128:129], v[128:129], v[188:189]
v_pk_add_f32 v[130:131], v[130:131], v[190:191]
v_pk_add_f32 v[132:133], v[132:133], v[192:193]
v_pk_add_f32 v[134:135], v[134:135], v[194:195]
v_pk_add_f32 v[136:137], v[136:137], v[196:197]
v_pk_add_f32 v[138:139], v[138:139], v[198:199]
s_waitcnt lgkmcnt(5)
v_pk_add_f32 v[120:121], v[120:121], v[200:201]
v_pk_add_f32 v[122:123], v[122:123], v[202:203]
v_pk_add_f32 v[124:125], v[124:125], v[204:205]
v_pk_add_f32 v[126:127], v[126:127], v[206:207]
v_pk_add_f32 v[128:129], v[128:129], v[208:209]
v_pk_add_f32 v[130:131], v[130:131], v[210:211]
v_pk_add_f32 v[132:133], v[132:133], v[212:213]
v_pk_add_f32 v[134:135], v[134:135], v[214:215]
v_pk_add_f32 v[136:137], v[136:137], v[216:217]
v_pk_add_f32 v[138:139], v[138:139], v[218:219]
s_waitcnt lgkmcnt(0)
v_pk_add_f32 v[120:121], v[120:121], v[220:221]
v_pk_add_f32 v[122:123], v[122:123], v[222:223]
v_pk_add_f32 v[124:125], v[124:125], v[224:225]
v_pk_add_f32 v[126:127], v[126:127], v[226:227]
v_pk_add_f32 v[128:129], v[128:129], v[228:229]
v_pk_add_f32 v[130:131], v[130:131], v[230:231]
v_pk_add_f32 v[132:133], v[132:133], v[232:233]
v_pk_add_f32 v[134:135], v[134:135], v[234:235]
v_pk_add_f32 v[136:137], v[136:137], v[236:237]
v_pk_add_f32 v[138:139], v[138:139], v[238:239]
s_waitcnt vmcnt(4)
v_mfma_f32_16x16x32_bf16 v[28:31], v[144:147], v[10:13], v[28:31]
s_waitcnt vmcnt(3)
v_mfma_f32_16x16x32_bf16 v[44:47], v[148:151], v[10:13], v[44:47]
s_waitcnt vmcnt(2)
v_mfma_f32_16x16x32_bf16 v[60:63], v[152:155], v[10:13], v[60:63]
s_waitcnt vmcnt(1)
v_mfma_f32_16x16x32_bf16 v[76:79], v[156:159], v[10:13], v[76:79]
s_waitcnt vmcnt(0)
v_mfma_f32_16x16x32_bf16 v[92:95], v[160:163], v[10:13], v[92:95]
v_pk_add_f32 v[120:121], v[120:121], v[28:29]
v_pk_add_f32 v[122:123], v[122:123], v[30:31]
v_pk_add_f32 v[124:125], v[124:125], v[44:45]
v_pk_add_f32 v[126:127], v[126:127], v[46:47]
v_pk_add_f32 v[128:129], v[128:129], v[60:61]
v_pk_add_f32 v[130:131], v[130:131], v[62:63]
v_pk_add_f32 v[132:133], v[132:133], v[76:77]
v_pk_add_f32 v[134:135], v[134:135], v[78:79]
v_pk_add_f32 v[136:137], v[136:137], v[92:93]
v_pk_add_f32 v[138:139], v[138:139], v[94:95]
v_cvt_pk_bf16_f32 v108, v120, v121
v_cvt_pk_bf16_f32 v109, v122, v123
v_cvt_pk_bf16_f32 v110, v124, v125
v_cvt_pk_bf16_f32 v111, v126, v127
v_cvt_pk_bf16_f32 v112, v128, v129
v_cvt_pk_bf16_f32 v113, v130, v131
v_cvt_pk_bf16_f32 v114, v132, v133
v_cvt_pk_bf16_f32 v115, v134, v135
v_cvt_pk_bf16_f32 v116, v136, v137
v_cvt_pk_bf16_f32 v117, v138, v139
v_and_b32 v180, 15, v1
v_mul_u32_u24 v180, 160, v180
v_lshrrev_b32 v181, 4, v1
v_mul_u32_u24 v181, 40, v181
v_add_u32 v180, v180, v181
s_mul_i32 s70, s52, 15360
v_add_u32 v180, s70, v180
ds_write_b64 v180, v[108:109] offset:0
ds_write_b64 v180, v[110:111] offset:8
ds_write_b64 v180, v[112:113] offset:16
ds_write_b64 v180, v[114:115] offset:24
ds_write_b64 v180, v[116:117] offset:32
v_add_u32 v182, 0, v1
v_mul_u32_u24 v183, 6554, v182
v_lshrrev_b32 v183, 16, v183
v_mul_u32_u24 v184, 1120, v183
v_lshlrev_b32 v182, 4, v182
v_add_u32 v184, v184, v182
v_add_u32 v182, 64, v1
v_mul_u32_u24 v183, 6554, v182
v_lshrrev_b32 v183, 16, v183
v_mul_u32_u24 v185, 1120, v183
v_lshlrev_b32 v182, 4, v182
v_add_u32 v185, v185, v182
v_add_u32 v182, 128, v1
v_mul_u32_u24 v183, 6554, v182
v_lshrrev_b32 v183, 16, v183
v_mul_u32_u24 v186, 1120, v183
v_lshlrev_b32 v182, 4, v182
v_add_u32 v186, v186, v182
s_waitcnt lgkmcnt(0)
ds_read_b128 v[188:191], v23 offset:0
ds_read_b128 v[192:195], v23 offset:1024
ds_read_b128 v[196:199], v23 offset:2048
s_waitcnt lgkmcnt(2)
buffer_store_dwordx4 v[188:191], v184, s[44:47], s64 offen sc0 sc1
s_waitcnt lgkmcnt(1)
buffer_store_dwordx4 v[192:195], v185, s[44:47], s64 offen sc0 sc1
s_waitcnt lgkmcnt(0)
s_mov_b32 exec_hi, 0
buffer_store_dwordx4 v[196:199], v186, s[44:47], s64 offen sc0 sc1
s_mov_b64 exec, -1
L_A_end:
s_endpgm
.section .rodata,"a"
.p2align 6
.amdhsa_kernel parallel_sum__ssm_conv_s4__dense_activation_mish__prompt_kernel
  .amdhsa_next_free_vgpr 256
  .amdhsa_next_free_sgpr 102
  .amdhsa_accum_offset 256
  .amdhsa_group_segment_fixed_size 0
  .amdhsa_kernarg_size 128
  .amdhsa_user_sgpr_count 2
  .amdhsa_user_sgpr_kernarg_segment_ptr 1
  .amdhsa_system_sgpr_workgroup_id_x 1
.end_amdhsa_kernel
```
